```python
import torch

def _softmax(x, axis=-1):
    return torch.softmax(x, dim=axis)
def _gelu(x):
    return torch.nn.functional.gelu(x, approximate="tanh")
def _silu(x):
    return torch.nn.functional.silu(x)
def _sigmoid(x):
    return torch.sigmoid(x)
def _layernorm(x, axis=-1, eps=1e-5):
    m = x.mean(dim=axis, keepdim=True)
    v = x.var(dim=axis, keepdim=True, unbiased=False)
    return (x - m) / torch.sqrt(v + eps)
def _scatter_add(tgt, idx, src, axis=0):
    return tgt.clone().index_add_(axis, idx, src)
def _segment_sum(src, seg, n):
    out = torch.zeros((n,) + src.shape[1:], dtype=src.dtype)
    return out.index_add_(0, seg, src)
def _pad(x, pw):
    flat = tuple(v for pair in reversed(pw) for v in pair)
    return torch.nn.functional.pad(x, flat)

kernel_name = 'interleave_layers__linear_attn_block__dense_activation_relu__prompt'

def setup_inputs():

    _w = (lambda a: (lambda t: t.to(torch.bfloat16) if t.is_floating_point() else t)(torch.as_tensor(a)))
    def _A_setup():
        B, S, D = 1, 2048, 512
        return {
            "x": _w((lambda *s: torch.randn(*s, dtype=torch.bfloat16) * 0.05)(B, S, D)),
            "wqkv": _w((lambda *s: torch.randn(*s, dtype=torch.bfloat16) * 0.05)(D, 3 * D)),
            "wo": _w((lambda *s: torch.randn(*s, dtype=torch.bfloat16) * 0.05)(D, D)),
        }
    _A_in = _A_setup()

    def _B_setup():
        B, S, D, Dff = 1, 2048, 512, 1792
        return {
            "x": _w((lambda *s: torch.randn(*s, dtype=torch.bfloat16) * 0.05)(B, S, D)),
            "w1": _w((lambda *s: torch.randn(*s, dtype=torch.bfloat16) * 0.05)(D, Dff)),
            "w2": _w((lambda *s: torch.randn(*s, dtype=torch.bfloat16) * 0.05)(Dff, D)),
        }
    _B_in = _B_setup()

    return {
        "A_x": _A_in["x"],
        "A_wqkv": _A_in["wqkv"],
        "A_wo": _A_in["wo"],
        "B_x": _B_in["x"],
        "B_w1": _B_in["w1"],
        "B_w2": _B_in["w2"],
    }

def reference(A_x, A_wqkv, A_wo, B_x, B_w1, B_w2):
    def _A_ref(x, wqkv, wo):
        B, S, D = x.shape
        H = 32; Dh = D // H
        qkv = (lambda x, *d: x.permute(*d))((x @ wqkv).reshape(B, S, 3, H, Dh), 2, 0, 3, 1, 4)
        q, k, v = qkv[0], qkv[1], qkv[2]
        phi = lambda t: torch.where(t > 0, t + 1, torch.exp(t)) + 1e-6
        pq, pk = phi(q), phi(k)
        kv = torch.einsum("bhsd,bhse->bhde", pk, v)
        z = torch.einsum("bhsd->bhd", pk)
        num = torch.einsum("bhqd,bhde->bhqe", pq, kv)
        den = torch.einsum("bhqd,bhd->bhq", pq, z)[..., None] + 1e-6
        o = num / den
        return (lambda x, *d: x.permute(*d))(o, 0, 2, 1, 3).reshape(B, S, D) @ wo

    def _B_ref(x, w1, w2):
        h = torch.einsum("bsd,df->bsf", x, w1)
        zero = torch.zeros_like(h)
        h = torch.maximum(h, zero)
        return torch.einsum("bsf,fd->bsd", h, w2)

    x = A_x
    x = x + _A_ref(_layernorm(x, axis=-1), A_wqkv, A_wo)
    x = x + _B_ref(_layernorm(x, axis=-1), B_w1, B_w2)
    x = x + _A_ref(_layernorm(x, axis=-1), A_wqkv, A_wo)
    x = x + _B_ref(_layernorm(x, axis=-1), B_w1, B_w2)
    return x
```

```asm
; @launch grid=(256,1,1) block=(256,1,1) lds=163840
.amdgcn_target "amdgcn-amd-amdhsa--gfx950"
.text
.globl interleave_layers__linear_attn_block__dense_activation_relu__prompt_kernel
.p2align 8
.type interleave_layers__linear_attn_block__dense_activation_relu__prompt_kernel,@function
interleave_layers__linear_attn_block__dense_activation_relu__prompt_kernel:
  s_load_dwordx2 s[4:5], s[0:1], 0
  s_load_dwordx2 s[8:9], s[0:1], 8
  s_load_dwordx2 s[16:17], s[0:1], 64
  s_cmp_ge_u32 s2, 256
  s_cbranch_scc1 Lend
  s_getpc_b64 s[92:93]
Lpc:
  s_lshr_b32 s34, s2, 3
  v_lshrrev_b32 v31, 6, v0
  v_lshl_add_u32 v30, s34, 4, v0
  v_readfirstlane_b32 s32, v31
  v_lshlrev_b32 v30, 7, v30
  v_min_u32 v30, Lend-Lpc, v30
  s_cmp_lg_u32 s32, 0
  s_cbranch_scc1 L1
  s_mov_b64 exec, 0xffff
  global_load_dword v239, v30, s[92:93]
  s_mov_b64 exec, -1
L1:
  v_and_b32 v0, 63, v0
  s_and_b32 s33, s2, 7
  s_and_b32 s35, s34, 1
  s_lshr_b32 s36, s34, 1
  s_lshl1_add_u32 s37, s33, s35
  s_lshl2_add_u32 s63, s37, s32
  s_lshl2_add_u32 s71, s35, s33
  s_lshl4_add_u32 s47, s37, s36
  s_lshl2_add_u32 s47, s47, s32
  v_lshlrev_b32 v1, 4, v0
  v_lshrrev_b32 v30, 2, v0
  v_and_b32 v31, 48, v1
  s_movk_i32 s90, 3072
  v_mad_u32_u24 v134, v30, s90, v31
  s_mul_i32 s75, s32, s90
  s_lshl2_add_u32 s74, s36, s75
  s_lshl_b32 s74, s74, 4
  s_nop 0
  s_mov_b32 s10, 1572864
  s_mov_b32 s11, 0x20000
  s_mov_b32 s6, 2097152
  s_mov_b32 s7, 0x20000
  s_mov_b32 s18, 67108864
  s_mov_b32 s19, 0x20000
  v_mov_b32 v240, -1
  v_mov_b32 v241, -1
  v_mov_b32 v242, -1
  v_mov_b32_e64 v243, -1
  s_lshl_b32 s88, s2, 13
  s_add_u32 s89, s88, 4096
  s_cmp_lt_u32 s2, 44
  s_cselect_b32 s79, s32, 0
  s_cmp_lg_u32 s79, 3
  s_waitcnt lgkmcnt(0)
  s_cbranch_scc1 L2
  s_nop 0
  buffer_store_dwordx4 v[240:243], v1, s[16:19], s88 offen offset:0 sc1
  buffer_store_dwordx4 v[240:243], v1, s[16:19], s88 offen offset:1024 sc1
  buffer_store_dwordx4 v[240:243], v1, s[16:19], s88 offen offset:2048 sc1
  buffer_store_dwordx4 v[240:243], v1, s[16:19], s88 offen offset:3072 sc1
  buffer_store_dwordx4 v[240:243], v1, s[16:19], s89 offen offset:0 sc1
  buffer_store_dwordx4 v[240:243], v1, s[16:19], s89 offen offset:1024 sc1
  buffer_store_dwordx4 v[240:243], v1, s[16:19], s89 offen offset:2048 sc1
  buffer_store_dwordx4 v[240:243], v1, s[16:19], s89 offen offset:3072 sc1
L2:
  s_add_u32 m0, s75, 0
  s_add_u32 s89, s71, 0
  s_and_b32 s89, s89, 7
  s_mul_i32 s89, s89, 196608
  s_add_u32 s89, s89, s74
  buffer_load_dwordx4 v134, s[8:11], s89 offen offset:1024 lds
  s_add_u32 m0, s75, 0
  s_nop 0
  buffer_load_dwordx4 v134, s[8:11], s89 offen offset:2048 lds
  s_add_u32 m0, s75, 0
  s_xor_b32 s89, s89, 512
  buffer_load_dwordx4 v134, s[8:11], s89 offen offset:0 lds
  s_lshl_b32 s88, s47, 11
  buffer_load_dwordx4 v[224:227], v1, s[4:7], s88 offen offset:0
  buffer_load_dwordx4 v[228:231], v1, s[4:7], s88 offen offset:1024
  v_lshrrev_b32 v30, 4, v0
  v_and_b32 v80, 7, v0
  v_xor_b32 v81, v80, v30
  v_lshlrev_b32 v81, 4, v81
  v_lshrrev_b32_e64 v31, 3, v0
  v_lshl_add_u32 v132, v31, 10, v81
  v_xor_b32 v133, 64, v132
  s_lshl_b32 s72, s63, 15
  s_lshl2_add_u32 s73, s75, 98304
  s_add_u32 m0, s73, 0
  s_add_u32 s88, s71, 0
  s_and_b32 s88, s88, 7
  s_lshl_b32 s88, s88, 7
  s_add_u32 s88, s88, s72
  s_nop 0
  buffer_load_dwordx4 v132, s[4:7], s88 offen lds
  s_add_u32 m0, s73, 1024
  s_add_u32 s88, s88, 8192
  buffer_load_dwordx4 v133, s[4:7], s88 offen lds
  s_add_u32 m0, s73, 2048
  s_add_u32 s88, s88, 8192
  buffer_load_dwordx4 v132, s[4:7], s88 offen lds
  s_add_u32 m0, s73, 3072
  s_add_u32 s88, s88, 8192
  buffer_load_dwordx4 v133, s[4:7], s88 offen lds
  s_load_dwordx2 s[20:21], s[0:1], 56
  s_load_dwordx2 s[98:99], s[0:1], 16
  s_load_dwordx2 s[24:25], s[0:1], 32
  s_load_dwordx2 s[28:29], s[0:1], 40
  s_load_dwordx2 s[12:13], s[0:1], 48
  s_and_b32 s38, s36, 1
  s_lshr_b32 s39, s36, 1
  s_lshl1_add_u32 s46, s37, s38
  s_lshr_b32 s90, s32, 1
  s_lshl1_add_u32 s46, s46, s90
  s_mov_b32 s22, 256
  s_mov_b32 s23, 0x20000
  s_add_u32 m0, s75, 12288
  s_add_u32 s89, s71, 1
  s_and_b32 s89, s89, 7
  s_mul_i32 s89, s89, 196608
  s_add_u32 s89, s89, s74
  buffer_load_dwordx4 v134, s[8:11], s89 offen offset:1024 lds
  s_add_u32 m0, s75, 12288
  s_nop 0
  buffer_load_dwordx4 v134, s[8:11], s89 offen offset:2048 lds
  s_add_u32 m0, s75, 12288
  s_xor_b32 s89, s89, 512
  buffer_load_dwordx4 v134, s[8:11], s89 offen offset:0 lds
  s_and_b32 s91, s32, 1
  v_and_b32 v48, 15, v0
  v_lshrrev_b32 v49, 4, v0
  v_and_b32 v50, 31, v0
  v_lshrrev_b32 v51, 5, v0
  v_bfe_u32 v52, v0, 2, 2
  v_and_b32_e64 v53, 3, v0
  v_bfe_u32 v54, v0, 1, 3
  v_xor_b32 v54, v51, v54
  v_lshlrev_b32 v54, 4, v54
  v_lshl_add_u32 v54, v50, 7, v54
  v_add_u32 v128, s73, v54
  v_xor_b32 v129, 32, v128
  v_xor_b32_e64 v130, 64, v128
  v_xor_b32 v131, 96, v128
  v_and_b32 v54, 1, v49
  v_lshlrev_b32 v54, 5, v54
  v_lshl_add_u32 v56, v53, 3, v54
  v_lshl_add_u32 v55, v51, 3, v52
  v_lshl_add_u32 v137, v55, 6, v56
  v_add_u32 v138, 49152, v137
  s_cmp_eq_u32 s32, 3
  s_cselect_b32 s76, 0, s32
  s_lshl_b32 s90, s76, 10
  v_add_u32 v139, s90, v137
  v_add_u32 v140, s90, v138
  v_xor_b32 v54, v49, v0
  v_and_b32 v54, 1, v54
  v_cmp_eq_u32 vcc, 0, v54
  v_mov_b32 v55, 0x3f803f80
  s_nop 0
  v_cndmask_b32 v152, 0, v55, vcc
  v_mov_b32 v153, v152
  v_mov_b32 v154, v152
  v_mov_b32_e64 v155, v152
  v_lshl_add_u32 v54, v51, 2, v52
  v_lshlrev_b32_e64 v54, 6, v54
  v_add3_u32 v220, v54, v56, s75
  v_add_u32 v221, 49152, v220
  v_bfe_u32 v54, v0, 1, 3
  s_lshl_b32 s90, s91, 2
  v_xor_b32 v54, s90, v54
  v_lshlrev_b32_e64 v54, 4, v54
  v_lshl_add_u32 v54, v50, 7, v54
  v_lshl_add_u32 v54, v51, 3, v54
  s_and_b32 s90, s46, 3
  s_mul_i32 s90, s90, 12288
  s_add_u32 s90, s90, 98304
  v_add_u32 v74, s90, v54
  v_xor_b32 v75, 16, v74
  v_xor_b32 v76, 32, v74
  v_xor_b32 v77, 48, v74
  s_sub_u32 s78, s39, s71
  s_and_b32 s78, s78, 7
  v_lshlrev_b32 v27, 3, v0
  v_lshlrev_b32_e64 v28, 2, v0
  v_min_u32 v255, 172, v28
  s_add_u32 m0, s73, 4096
  s_add_u32 s88, s71, 1
  s_and_b32 s88, s88, 7
  s_lshl_b32 s88, s88, 7
  s_add_u32 s88, s88, s72
  buffer_load_dwordx4 v132, s[4:7], s88 offen lds
  s_add_u32 m0, s73, 5120
  s_add_u32 s88, s88, 8192
  buffer_load_dwordx4 v133, s[4:7], s88 offen lds
  s_add_u32 m0, s73, 6144
  s_add_u32 s88, s88, 8192
  buffer_load_dwordx4 v132, s[4:7], s88 offen lds
  s_add_u32 m0, s73, 7168
  s_add_u32 s88, s88, 8192
  buffer_load_dwordx4 v133, s[4:7], s88 offen lds
  s_waitcnt lgkmcnt(0)
  s_cmp_lg_u32 s79, 3
  s_cbranch_scc1 L3
  s_lshl_b32 s96, s2, 2
  v_mov_b32_e64 v30, 1
  s_mov_b64 exec, 1
  s_waitcnt vmcnt(16)
  buffer_store_dword v30, off, s[20:23], s96 sc1
  s_mov_b64 exec, -1
L3:
  s_add_u32 m0, s75, 24576
  s_add_u32 s89, s71, 2
  s_and_b32 s89, s89, 7
  s_mul_i32 s89, s89, 196608
  s_add_u32 s89, s89, s74
  buffer_load_dwordx4 v134, s[8:11], s89 offen offset:1024 lds
  s_add_u32 m0, s75, 24576
  s_nop 0
  buffer_load_dwordx4 v134, s[8:11], s89 offen offset:2048 lds
  s_add_u32 m0, s75, 24576
  s_xor_b32 s89, s89, 512
  buffer_load_dwordx4 v134, s[8:11], s89 offen offset:0 lds
  s_waitcnt vmcnt(10)
  s_barrier
  s_cmp_lg_u32 s78, 0
  s_cbranch_scc1 L4
  s_nop 0
  ds_read_b64 v[240:241], v74 offset:0
  ds_read_b64 v[242:243], v75 offset:0
  ds_read_b64 v[244:245], v76 offset:0
  ds_read_b64 v[246:247], v77 offset:0
L4:
  ds_read_b128 v[188:191], v128 offset:0
  ds_read_b128 v[192:195], v129 offset:0
  ds_read_b128 v[196:199], v130 offset:0
  ds_read_b128 v[200:203], v131 offset:0
  ds_read_b64_tr_b16 v[156:157], v137 offset:1024
  ds_read_b64_tr_b16 v[158:159], v137 offset:1280
  ds_read_b64_tr_b16 v[160:161], v137 offset:2048
  ds_read_b64_tr_b16 v[162:163], v137 offset:2304
  ds_read_b64_tr_b16 v[164:165], v137 offset:0
  ds_read_b64_tr_b16 v[166:167], v137 offset:256
  ds_read_b64_tr_b16 v[168:169], v139 offset:0
  ds_read_b64_tr_b16 v[170:171], v139 offset:256
  ds_read_b64_tr_b16 v[172:173], v137 offset:4096
  ds_read_b64_tr_b16 v[174:175], v137 offset:4352
  s_waitcnt lgkmcnt(8)
  v_mfma_f32_32x32x16_bf16 v[96:111], v[188:191], v[156:159], 0
  ds_read_b64_tr_b16 v[176:177], v137 offset:5120
  ds_read_b64_tr_b16 v[178:179], v137 offset:5376
  s_add_u32 m0, s73, 8192
  s_add_u32 s88, s71, 2
  s_and_b32 s88, s88, 7
  s_lshl_b32 s88, s88, 7
  s_add_u32 s88, s88, s72
  buffer_load_dwordx4 v132, s[4:7], s88 offen lds
  ds_read_b64_tr_b16 a[112:113], v220 offset:0
  ds_read_b64_tr_b16 a[114:115], v220 offset:512
  s_waitcnt lgkmcnt(10)
  v_mfma_f32_32x32x16_bf16 v[112:127], v[188:191], v[160:163], 0
  ds_read_b64_tr_b16 v[180:181], v137 offset:3072
  ds_read_b64_tr_b16 v[182:183], v137 offset:3328
  ds_read_b64_tr_b16 a[116:117], v220 offset:1024
  ds_read_b64_tr_b16 a[118:119], v220 offset:1536
  s_waitcnt lgkmcnt(12)
  v_mfma_f32_32x32x16_bf16 v[80:95], v[164:167], v[188:191], 0
  s_nop 0
  ds_read_b64_tr_b16 v[184:185], v139 offset:3072
  ds_read_b64_tr_b16 v[186:187], v139 offset:3328
  s_add_u32 m0, s73, 9216
  s_add_u32 s88, s88, 8192
  buffer_load_dwordx4 v133, s[4:7], s88 offen lds
  ds_read_b64_tr_b16 a[120:121], v220 offset:2048
  ds_read_b64_tr_b16 a[122:123], v220 offset:2560
  s_waitcnt lgkmcnt(14)
  v_mfma_f32_16x16x32_bf16 v[148:151], v[152:155], v[168:171], 0
  ds_read_b64_tr_b16 v[156:157], v137 offset:7168
  ds_read_b64_tr_b16 v[158:159], v137 offset:7424
  s_waitcnt lgkmcnt(14)
  v_mfma_f32_32x32x16_bf16 v[96:111], v[192:195], v[172:175], v[96:111]
  ds_read_b64_tr_b16 v[160:161], v137 offset:8192
  ds_read_b64_tr_b16 v[162:163], v137 offset:8448
  s_add_u32 m0, s73, 10240
  s_add_u32 s88, s88, 8192
  buffer_load_dwordx4 v132, s[4:7], s88 offen lds
  s_waitcnt lgkmcnt(14)
  v_mfma_f32_32x32x16_bf16 v[112:127], v[192:195], v[176:179], v[112:127]
  ds_read_b64_tr_b16 v[164:165], v137 offset:6144
  ds_read_b64_tr_b16 v[166:167], v137 offset:6400
  s_add_u32 m0, s73, 11264
  s_add_u32 s88, s88, 8192
  buffer_load_dwordx4 v133, s[4:7], s88 offen lds
  s_waitcnt lgkmcnt(12)
  v_mfma_f32_32x32x16_bf16 v[80:95], v[180:183], v[192:195], v[80:95]
  ds_read_b64_tr_b16 v[168:169], v139 offset:6144
  ds_read_b64_tr_b16 v[170:171], v139 offset:6400
  s_waitcnt lgkmcnt(10)
  v_mfma_f32_16x16x32_bf16 v[148:151], v[152:155], v[184:187], v[148:151]
  ds_read_b64_tr_b16 v[172:173], v137 offset:10240
  ds_read_b64_tr_b16 v[174:175], v137 offset:10496
  s_add_u32 m0, s75, 36864
  s_add_u32 s89, s71, 3
  s_and_b32 s89, s89, 7
  s_mul_i32 s89, s89, 196608
  s_add_u32 s89, s89, s74
  buffer_load_dwordx4 v134, s[8:11], s89 offen offset:1024 lds
  s_waitcnt lgkmcnt(8)
  v_mfma_f32_32x32x16_bf16 v[96:111], v[196:199], v[156:159], v[96:111]
  ds_read_b64_tr_b16 v[176:177], v137 offset:11264
  ds_read_b64_tr_b16 v[178:179], v137 offset:11520
  s_waitcnt lgkmcnt(8)
  v_mfma_f32_32x32x16_bf16 v[112:127], v[196:199], v[160:163], v[112:127]
  ds_read_b64_tr_b16 v[180:181], v137 offset:9216
  ds_read_b64_tr_b16 v[182:183], v137 offset:9472
  s_waitcnt lgkmcnt(8)
  v_mfma_f32_32x32x16_bf16 v[80:95], v[164:167], v[196:199], v[80:95]
  ds_read_b64_tr_b16 v[184:185], v139 offset:9216
  ds_read_b64_tr_b16 v[186:187], v139 offset:9472
  s_add_u32 m0, s75, 36864
  s_nop 0
  buffer_load_dwordx4 v134, s[8:11], s89 offen offset:2048 lds
  s_waitcnt lgkmcnt(8)
  v_mfma_f32_16x16x32_bf16 v[148:151], v[152:155], v[168:171], v[148:151]
  s_mov_b32 s48, 0x358637bd
  s_mov_b32 s49, 0x358637bd
  s_mov_b32 s50, 0x3fb8aa3b
  s_mov_b32 s51, 0x3fb8aa3b
  s_mov_b32 s52, -1
  s_mov_b32 s53, 0
  s_mov_b32 s54, 65535
  s_mov_b32 s55, 0
  s_mov_b32 s56, 4294901760
  s_mov_b32 s57, 0
  s_mov_b32 s58, 4294901760
  s_mov_b32 s59, 4294901760
  s_getreg_b32 s45, hwreg(HW_REG_XCC_ID)
  s_and_b32 s45, s45, 15
  v_bfe_u32 v30, v0, 4, 1
  v_and_b32 v54, 7, v0
  v_lshrrev_b32 v55, 3, v0
  v_lshlrev_b32 v30, 2, v30
  v_xor_b32 v54, v54, v30
  v_lshlrev_b32 v54, 4, v54
  v_lshl_add_u32 v142, v55, 10, v54
  v_mul_u32_u24 v141, 3584, v55
  v_add_u32 v141, v141, v54
  s_lshl2_add_u32 s87, s2, s32
  s_mov_b32 s64, s98
  s_mov_b32 s65, s99
  s_mov_b32 s66, 524288
  s_mov_b32 s67, 0x20000
  s_lshl_b32 s82, s87, 9
  v_lshlrev_b32 v143, 7, v0
  s_mul_i32 s90, s87, 2341
  s_lshr_b32 s90, s90, 16
  s_mul_i32 s91, s90, 28
  s_sub_u32 s91, s87, s91
  s_mul_i32 s92, s90, 57344
  s_lshl_b32 s93, s91, 7
  s_add_u32 s80, s92, s93
  s_lshl_b32 s92, s87, 11
  s_add_u32 s83, s92, 18874368
  s_lshr_b32 s90, s87, 3
  s_and_b32 s91, s87, 7
  s_lshl_b32 s92, s90, 14
  s_lshl_b32 s93, s91, 7
  s_add_u32 s81, s92, s93
  s_mul_i32 s92, s90, 10923
  s_lshr_b32 s92, s92, 16
  s_add_u32 s92, s92, s90
  s_mul_i32 s93, s90, 7
  s_sub_u32 s93, s93, 666
  s_cmp_lt_u32 s90, 96
  s_cselect_b32 s92, s92, s93
  s_mul_i32 s93, s92, 4682
  s_lshr_b32 s93, s93, 16
  s_mul_i32 s93, s93, 14
  s_sub_u32 s90, s92, s93
  s_lshl_b32 s92, s92, 14
  s_lshl_b32 s93, s91, 11
  s_add_u32 s92, s92, s93
  s_add_u32 s84, s92, 20971520
  s_cmp_ge_u32 s90, 8
  s_cselect_b32 s84, s84, s18
  s_cmp_lt_u32 s87, 896
  s_cselect_b32 s80, s80, s18
  s_cselect_b32 s83, s83, s18
  s_cselect_b32 s81, s81, s18
  s_cselect_b32 s84, s84, s18
  s_mov_b32 s26, 1835008
  s_mov_b32 s27, 0x20000
  s_mov_b32 s30, 1835008
  s_mov_b32 s31, 0x20000
  s_lshl_b32 s86, s32, 12
  s_add_u32 s86, s86, 147456
  s_and_b32 s91, s32, 1
  s_lshl_b32 s62, s46, 12
  s_lshl_b32 s92, s39, 9
  s_add_u32 s62, s62, s92
  s_lshl_b32 s92, s91, 3
  s_add_u32 s62, s62, s92
  s_lshl_b32 s90, s36, 1
  s_lshr_b32 s92, s32, 1
  s_add_u32 s90, s90, s92
  s_lshl_b32 s90, s90, 4
  s_add_u32 s90, s90, s37
  s_mul_i32 s90, s90, 640
  s_mul_i32 s92, s91, 256
  s_add_u32 s70, s90, s92
  s_mul_i32 s43, s91, 15
  v_lshl_add_u32 v54, v51, 2, v52
  v_lshrrev_b32 v55, 1, v52
  v_lshlrev_b32 v55, 6, v55
  v_xor_b32 v55, v55, v56
  v_lshl_add_u32 v54, v54, 7, v55
  v_add_u32 v144, s86, v54
  v_xor_b32 v145, 64, v144
  s_lshl_b32 s90, s32, 11
  v_add_u32 v17, s90, v54
  s_lshl_b32 s90, s91, 6
  v_xor_b32 v17, s90, v17
  v_mov_b32 v8, v142
  v_and_b32 v56, 1, v49
  v_lshlrev_b32_e64 v54, 3, v50
  v_add_u32 v16, 147456, v54
  s_mul_i32 s96, s32, 2304
  s_add_u32 s96, s96, 151552
  v_mul_u32_u24 v54, 1088, v56
  v_add_u32_e64 v54, s96, v54
  v_lshl_add_u32 v55, v48, 6, v54
  v_lshl_add_u32 v21, v51, 5, v55
  v_bfe_u32 v55, v0, 2, 1
  v_lshl_add_u32 v55, v55, 3, v53
  v_bfe_u32 v30, v0, 3, 1
  v_lshl_add_u32 v55, v30, 2, v55
  v_lshl_add_u32 v55, v55, 2, v54
  v_add_u32 v22, 1024, v55
  s_lshl_b32 s90, s32, 7
  s_add_u32 s90, s90, 147456
  v_lshl_add_u32 v23, v51, 4, s90
  v_lshl_add_u32 v24, v50, 2, s90
  s_mul_i32 s90, s32, 544
  s_lshl_b32 s92, s91, 5
  s_sub_u32 s90, s90, s92
  s_add_u32 s90, s90, 151552
  v_add_u32 v26, s90, v1
  s_waitcnt vmcnt(9)
  s_barrier
  s_cmp_lg_u32 s78, 1
  s_cbranch_scc1 L5
  ds_read_b64 v[240:241], v74 offset:4096
  ds_read_b64 v[242:243], v75 offset:4096
  ds_read_b64 v[244:245], v76 offset:4096
  ds_read_b64 v[246:247], v77 offset:4096
L5:
  ds_read_b128 v[204:207], v128 offset:4096
  ds_read_b128 v[208:211], v129 offset:4096
  ds_read_b128 v[212:215], v130 offset:4096
  ds_read_b128 v[216:219], v131 offset:4096
  ds_read_b64_tr_b16 v[156:157], v137 offset:13312
  ds_read_b64_tr_b16 v[158:159], v137 offset:13568
  s_waitcnt lgkmcnt(12)
  v_mfma_f32_32x32x16_bf16 v[96:111], v[200:203], v[172:175], v[96:111]
  ds_read_b64_tr_b16 v[160:161], v137 offset:14336
  ds_read_b64_tr_b16 v[162:163], v137 offset:14592
  s_waitcnt lgkmcnt(12)
  v_mfma_f32_32x32x16_bf16 v[112:127], v[200:203], v[176:179], v[112:127]
  ds_read_b64_tr_b16 v[164:165], v137 offset:12288
  ds_read_b64_tr_b16 v[166:167], v137 offset:12544
  s_add_u32 m0, s75, 36864
  s_xor_b32 s89, s89, 512
  buffer_load_dwordx4 v134, s[8:11], s89 offen offset:0 lds
  s_waitcnt lgkmcnt(12)
  v_mfma_f32_32x32x16_bf16 v[80:95], v[180:183], v[200:203], v[80:95]
  ds_read_b64_tr_b16 v[168:169], v139 offset:12288
  ds_read_b64_tr_b16 v[170:171], v139 offset:12544
  s_waitcnt lgkmcnt(12)
  v_mfma_f32_16x16x32_bf16 v[148:151], v[152:155], v[184:187], v[148:151]
  ds_read_b64_tr_b16 v[172:173], v137 offset:16384
  ds_read_b64_tr_b16 v[174:175], v137 offset:16640
  s_waitcnt lgkmcnt(8)
  v_mfma_f32_32x32x16_bf16 v[96:111], v[204:207], v[156:159], v[96:111]
  ds_read_b64_tr_b16 v[176:177], v137 offset:17408
  ds_read_b64_tr_b16 v[178:179], v137 offset:17664
  s_add_u32 m0, s73, 0
  s_add_u32 s88, s71, 3
  s_and_b32 s88, s88, 7
  s_lshl_b32 s88, s88, 7
  s_add_u32 s88, s88, s72
  buffer_load_dwordx4 v132, s[4:7], s88 offen lds
  ds_read_b64_tr_b16 a[124:125], v220 offset:12288
  ds_read_b64_tr_b16 a[126:127], v220 offset:12800
  s_waitcnt lgkmcnt(10)
  v_mfma_f32_32x32x16_bf16 v[112:127], v[204:207], v[160:163], v[112:127]
  ds_read_b64_tr_b16 v[180:181], v137 offset:15360
  ds_read_b64_tr_b16 v[182:183], v137 offset:15616
  ds_read_b64_tr_b16 a[128:129], v220 offset:13312
  ds_read_b64_tr_b16 a[130:131], v220 offset:13824
  s_waitcnt lgkmcnt(12)
  v_mfma_f32_32x32x16_bf16 v[80:95], v[164:167], v[204:207], v[80:95]
  ds_read_b64_tr_b16 v[184:185], v139 offset:15360
  ds_read_b64_tr_b16 v[186:187], v139 offset:15616
  s_add_u32 m0, s73, 1024
  s_add_u32 s88, s88, 8192
  buffer_load_dwordx4 v133, s[4:7], s88 offen lds
  ds_read_b64_tr_b16 a[132:133], v220 offset:14336
  ds_read_b64_tr_b16 a[134:135], v220 offset:14848
  s_waitcnt lgkmcnt(14)
  v_mfma_f32_16x16x32_bf16 v[148:151], v[152:155], v[168:171], v[148:151]
  ds_read_b64_tr_b16 v[156:157], v137 offset:19456
  ds_read_b64_tr_b16 v[158:159], v137 offset:19712
  s_waitcnt lgkmcnt(14)
  v_mfma_f32_32x32x16_bf16 v[96:111], v[208:211], v[172:175], v[96:111]
  ds_read_b64_tr_b16 v[160:161], v137 offset:20480
  ds_read_b64_tr_b16 v[162:163], v137 offset:20736
  s_add_u32 m0, s73, 2048
  s_add_u32 s88, s88, 8192
  buffer_load_dwordx4 v132, s[4:7], s88 offen lds
  s_waitcnt lgkmcnt(14)
  v_mfma_f32_32x32x16_bf16 v[112:127], v[208:211], v[176:179], v[112:127]
  ds_read_b64_tr_b16 v[164:165], v137 offset:18432
  ds_read_b64_tr_b16 v[166:167], v137 offset:18688
  s_add_u32 m0, s73, 3072
  s_add_u32 s88, s88, 8192
  buffer_load_dwordx4 v133, s[4:7], s88 offen lds
  s_waitcnt lgkmcnt(12)
  v_mfma_f32_32x32x16_bf16 v[80:95], v[180:183], v[208:211], v[80:95]
  ds_read_b64_tr_b16 v[168:169], v139 offset:18432
  ds_read_b64_tr_b16 v[170:171], v139 offset:18688
  s_waitcnt lgkmcnt(10)
  v_mfma_f32_16x16x32_bf16 v[148:151], v[152:155], v[184:187], v[148:151]
  ds_read_b64_tr_b16 v[172:173], v137 offset:22528
  ds_read_b64_tr_b16 v[174:175], v137 offset:22784
  s_add_u32 m0, s75, 49152
  s_add_u32 s89, s71, 4
  s_and_b32 s89, s89, 7
  s_mul_i32 s89, s89, 196608
  s_add_u32 s89, s89, s74
  buffer_load_dwordx4 v134, s[8:11], s89 offen offset:1024 lds
  s_waitcnt lgkmcnt(8)
  v_mfma_f32_32x32x16_bf16 v[96:111], v[212:215], v[156:159], v[96:111]
  ds_read_b64_tr_b16 v[176:177], v137 offset:23552
  ds_read_b64_tr_b16 v[178:179], v137 offset:23808
  s_waitcnt lgkmcnt(8)
  v_mfma_f32_32x32x16_bf16 v[112:127], v[212:215], v[160:163], v[112:127]
  ds_read_b64_tr_b16 v[180:181], v137 offset:21504
  ds_read_b64_tr_b16 v[182:183], v137 offset:21760
  s_waitcnt lgkmcnt(8)
  v_mfma_f32_32x32x16_bf16 v[80:95], v[164:167], v[212:215], v[80:95]
  ds_read_b64_tr_b16 v[184:185], v139 offset:21504
  ds_read_b64_tr_b16 v[186:187], v139 offset:21760
  s_add_u32 m0, s75, 49152
  s_nop 0
  buffer_load_dwordx4 v134, s[8:11], s89 offen offset:2048 lds
  s_waitcnt lgkmcnt(8)
  v_mfma_f32_16x16x32_bf16 v[148:151], v[152:155], v[168:171], v[148:151]
  v_mov_b32 v237, 0x3f803f80
  v_lshrrev_b32 v238, 2, v0
  v_dot2_f32_bf16 v232, v224, v237, 0
  v_dot2_f32_bf16 v234, v224, v224, 0
  v_dot2_f32_bf16 v233, v228, v237, 0
  v_dot2_f32_bf16 v235, v228, v228, 0
  v_dot2_f32_bf16 v232, v225, v237, v232
  v_dot2_f32_bf16 v234, v225, v225, v234
  v_dot2_f32_bf16 v233, v229, v237, v233
  v_dot2_f32_bf16 v235, v229, v229, v235
  v_dot2_f32_bf16 v232, v226, v237, v232
  v_dot2_f32_bf16 v234, v226, v226, v234
  v_dot2_f32_bf16 v233, v230, v237, v233
  v_dot2_f32_bf16 v235, v230, v230, v235
  v_dot2_f32_bf16 v232, v227, v237, v232
  v_dot2_f32_bf16 v234, v227, v227, v234
  v_dot2_f32_bf16 v233, v231, v237, v233
  v_dot2_f32_bf16 v235, v231, v231, v235
  s_nop 1
  v_permlane32_swap_b32 v232, v233
  v_permlane32_swap_b32 v234, v235
  v_add_f32 v232, v232, v233
  v_add_f32 v234, v234, v235
  s_nop 1
  v_permlane16_swap_b32 v232, v234
  v_add_f32_e64 v236, v232, v234
  s_nop 1
  v_add_f32_dpp v236, v236, v236 row_ror:8 row_mask:0xf bank_mask:0xf
  s_nop 1
  v_add_f32_dpp v236, v236, v236 row_ror:4 row_mask:0xf bank_mask:0xf
  s_nop 1
  v_add_f32_dpp v236, v236, v236 row_ror:2 row_mask:0xf bank_mask:0xf
  s_nop 1
  v_add_f32_dpp v236, v236, v236 row_ror:1 row_mask:0xf bank_mask:0xf
  v_min_u32 v236, -2, v236
  s_waitcnt vmcnt(9)
  s_barrier
  s_cmp_lg_u32 s78, 2
  s_cbranch_scc1 L6
  ds_read_b64 v[240:241], v74 offset:8192
  ds_read_b64 v[242:243], v75 offset:8192
  ds_read_b64 v[244:245], v76 offset:8192
  ds_read_b64 v[246:247], v77 offset:8192
L6:
  ds_read_b128 v[188:191], v128 offset:8192
  ds_read_b128 v[192:195], v129 offset:8192
  ds_read_b128 v[196:199], v130 offset:8192
  ds_read_b128 v[200:203], v131 offset:8192
  ds_read_b64_tr_b16 v[156:157], v137 offset:25600
  ds_read_b64_tr_b16 v[158:159], v137 offset:25856
  s_waitcnt lgkmcnt(12)
  v_mfma_f32_32x32x16_bf16 v[96:111], v[216:219], v[172:175], v[96:111]
  ds_read_b64_tr_b16 v[160:161], v137 offset:26624
  ds_read_b64_tr_b16 v[162:163], v137 offset:26880
  s_waitcnt lgkmcnt(12)
  v_mfma_f32_32x32x16_bf16 v[112:127], v[216:219], v[176:179], v[112:127]
  ds_read_b64_tr_b16 v[164:165], v137 offset:24576
  ds_read_b64_tr_b16 v[166:167], v137 offset:24832
  s_add_u32 m0, s75, 49152
  s_xor_b32 s89, s89, 512
  buffer_load_dwordx4 v134, s[8:11], s89 offen offset:0 lds
  s_waitcnt lgkmcnt(12)
  v_mfma_f32_32x32x16_bf16 v[80:95], v[180:183], v[216:219], v[80:95]
  ds_read_b64_tr_b16 v[168:169], v139 offset:24576
  ds_read_b64_tr_b16 v[170:171], v139 offset:24832
  s_waitcnt lgkmcnt(12)
  v_mfma_f32_16x16x32_bf16 v[148:151], v[152:155], v[184:187], v[148:151]
  ds_read_b64_tr_b16 v[172:173], v137 offset:28672
  ds_read_b64_tr_b16 v[174:175], v137 offset:28928
  s_waitcnt lgkmcnt(8)
  v_mfma_f32_32x32x16_bf16 v[96:111], v[188:191], v[156:159], v[96:111]
  ds_read_b64_tr_b16 v[176:177], v137 offset:29696
  ds_read_b64_tr_b16 v[178:179], v137 offset:29952
  buffer_load_dword v31, v255, s[20:23], 0 offen sc1
  ds_read_b64_tr_b16 a[136:137], v220 offset:24576
  ds_read_b64_tr_b16 a[138:139], v220 offset:25088
  s_waitcnt lgkmcnt(10)
  v_mfma_f32_32x32x16_bf16 v[112:127], v[188:191], v[160:163], v[112:127]
  ds_read_b64_tr_b16 v[180:181], v137 offset:27648
  ds_read_b64_tr_b16 v[182:183], v137 offset:27904
  s_add_u32 m0, s73, 4096
  s_add_u32 s88, s71, 4
  s_and_b32 s88, s88, 7
  s_lshl_b32 s88, s88, 7
  s_add_u32 s88, s88, s72
  buffer_load_dwordx4 v132, s[4:7], s88 offen lds
  ds_read_b64_tr_b16 a[140:141], v220 offset:25600
  ds_read_b64_tr_b16 a[142:143], v220 offset:26112
  s_waitcnt lgkmcnt(12)
  v_mfma_f32_32x32x16_bf16 v[80:95], v[164:167], v[188:191], v[80:95]
  s_nop 0
  ds_read_b64_tr_b16 v[184:185], v139 offset:27648
  ds_read_b64_tr_b16 v[186:187], v139 offset:27904
  s_add_u32 m0, s73, 5120
  s_add_u32 s88, s88, 8192
  buffer_load_dwordx4 v133, s[4:7], s88 offen lds
  ds_read_b64_tr_b16 a[144:145], v220 offset:26624
  ds_read_b64_tr_b16 a[146:147], v220 offset:27136
  s_waitcnt lgkmcnt(14)
  v_mfma_f32_16x16x32_bf16 v[148:151], v[152:155], v[168:171], v[148:151]
  ds_read_b64_tr_b16 v[156:157], v137 offset:31744
  ds_read_b64_tr_b16 v[158:159], v137 offset:32000
  s_add_u32 m0, s73, 6144
  s_add_u32 s88, s88, 8192
  buffer_load_dwordx4 v132, s[4:7], s88 offen lds
  s_waitcnt lgkmcnt(14)
  v_mfma_f32_32x32x16_bf16 v[96:111], v[192:195], v[172:175], v[96:111]
  ds_read_b64_tr_b16 v[160:161], v137 offset:32768
  ds_read_b64_tr_b16 v[162:163], v137 offset:33024
  s_add_u32 m0, s73, 7168
  s_add_u32 s88, s88, 8192
  buffer_load_dwordx4 v133, s[4:7], s88 offen lds
  s_waitcnt lgkmcnt(14)
  v_mfma_f32_32x32x16_bf16 v[112:127], v[192:195], v[176:179], v[112:127]
  ds_read_b64_tr_b16 v[164:165], v137 offset:30720
  ds_read_b64_tr_b16 v[166:167], v137 offset:30976
  s_add_u32 m0, s75, 61440
  s_add_u32 s89, s71, 5
  s_and_b32 s89, s89, 7
  s_mul_i32 s89, s89, 196608
  s_add_u32 s89, s89, s74
  buffer_load_dwordx4 v134, s[8:11], s89 offen offset:1024 lds
  s_waitcnt lgkmcnt(12)
  v_mfma_f32_32x32x16_bf16 v[80:95], v[180:183], v[192:195], v[80:95]
  ds_read_b64_tr_b16 v[168:169], v139 offset:30720
  ds_read_b64_tr_b16 v[170:171], v139 offset:30976
  s_waitcnt lgkmcnt(10)
  v_mfma_f32_16x16x32_bf16 v[148:151], v[152:155], v[184:187], v[148:151]
  ds_read_b64_tr_b16 v[172:173], v137 offset:34816
  ds_read_b64_tr_b16 v[174:175], v137 offset:35072
  s_add_u32 m0, s75, 61440
  s_nop 0
  buffer_load_dwordx4 v134, s[8:11], s89 offen offset:2048 lds
  s_waitcnt lgkmcnt(8)
  v_mfma_f32_32x32x16_bf16 v[96:111], v[196:199], v[156:159], v[96:111]
  ds_read_b64_tr_b16 v[176:177], v137 offset:35840
  ds_read_b64_tr_b16 v[178:179], v137 offset:36096
  s_waitcnt lgkmcnt(8)
  v_mfma_f32_32x32x16_bf16 v[112:127], v[196:199], v[160:163], v[112:127]
  ds_read_b64_tr_b16 v[180:181], v137 offset:33792
  ds_read_b64_tr_b16 v[182:183], v137 offset:34048
  s_add_u32 m0, s75, 61440
  s_xor_b32 s89, s89, 512
  buffer_load_dwordx4 v134, s[8:11], s89 offen offset:0 lds
  s_waitcnt lgkmcnt(8)
  v_mfma_f32_32x32x16_bf16 v[80:95], v[164:167], v[196:199], v[80:95]
  ds_read_b64_tr_b16 v[184:185], v139 offset:33792
  ds_read_b64_tr_b16 v[186:187], v139 offset:34048
  s_waitcnt lgkmcnt(8)
  v_mfma_f32_16x16x32_bf16 v[148:151], v[152:155], v[168:171], v[148:151]
  s_waitcnt vmcnt(7)
  v_cmp_eq_u32 vcc, 0, v31
  s_cbranch_vccz L7
  s_mov_b32 s44, 0
L8:
  s_sleep 4
  buffer_load_dword v31, v255, s[20:23], 0 offen sc1
  s_add_u32 s44, s44, 1
  s_cmp_gt_u32 s44, 200000
  s_cbranch_scc1 Lend
  s_waitcnt vmcnt(0)
  v_cmp_eq_u32_e64 vcc, 0, v31
  s_cbranch_vccnz L8
L7:
  s_barrier
  s_lshl_b32 s96, s47, 4
  s_add_u32 s96, s96, 344064
  s_mov_b32 exec_lo, 0x10001
  s_mov_b32 exec_hi, 0x10001
  buffer_store_dword v236, v238, s[16:19], s96 offen sc1
  s_lshl_b32 s96, s33, 5
  s_add_u32 s96, s96, s34
  s_lshl_b32 s96, s96, 2
  s_add_u32 s96, s96, 335872
  s_cmp_eq_u32 s32, 0
  s_cselect_b32 s96, s96, s18
  v_mov_b32_e64 v30, s45
  s_mov_b64 exec, 1
  buffer_store_dword v30, off, s[16:19], s96 sc1
  s_mov_b64 exec, -1
  s_cmp_lg_u32 s78, 3
  s_cbranch_scc1 L9
  s_nop 0
  ds_read_b64 v[240:241], v74 offset:0
  ds_read_b64 v[242:243], v75 offset:0
  ds_read_b64 v[244:245], v76 offset:0
  ds_read_b64 v[246:247], v77 offset:0
L9:
  ds_read_b128 v[204:207], v128 offset:0
  ds_read_b128 v[208:211], v129 offset:0
  ds_read_b128 v[212:215], v130 offset:0
  ds_read_b128 v[216:219], v131 offset:0
  ds_read_b64_tr_b16 v[156:157], v137 offset:37888
  ds_read_b64_tr_b16 v[158:159], v137 offset:38144
  s_add_u32 m0, s86, 0
  s_nop 0
  buffer_load_dwordx4 v141, s[24:27], s80 offen lds
  s_waitcnt lgkmcnt(12)
  v_mfma_f32_32x32x16_bf16 v[96:111], v[200:203], v[172:175], v[96:111]
  ds_read_b64_tr_b16 v[160:161], v137 offset:38912
  ds_read_b64_tr_b16 v[162:163], v137 offset:39168
  s_add_u32 m0, s86, 1024
  s_add_u32 s80, s80, 28672
  buffer_load_dwordx4 v141, s[24:27], s80 offen lds
  s_waitcnt lgkmcnt(12)
  v_mfma_f32_32x32x16_bf16 v[112:127], v[200:203], v[176:179], v[112:127]
  ds_read_b64_tr_b16 v[164:165], v137 offset:36864
  ds_read_b64_tr_b16 v[166:167], v137 offset:37120
  s_add_u32 m0, s86, 2048
  s_nop 0
  buffer_load_dwordx4 v142, s[28:31], s81 offen lds
  s_waitcnt lgkmcnt(12)
  v_mfma_f32_32x32x16_bf16 v[80:95], v[180:183], v[200:203], v[80:95]
  ds_read_b64_tr_b16 v[168:169], v139 offset:36864
  ds_read_b64_tr_b16 v[170:171], v139 offset:37120
  s_add_u32 m0, s86, 3072
  s_add_u32 s81, s81, 8192
  buffer_load_dwordx4 v142, s[28:31], s81 offen lds
  s_waitcnt lgkmcnt(12)
  v_mfma_f32_16x16x32_bf16 v[148:151], v[152:155], v[184:187], v[148:151]
  ds_read_b64_tr_b16 v[172:173], v137 offset:40960
  ds_read_b64_tr_b16 v[174:175], v137 offset:41216
  s_mov_b64 exec, 15
  buffer_load_dword v73, v143, s[64:67], s82 offen
  s_mov_b64 exec, -1
  s_waitcnt lgkmcnt(8)
  v_mfma_f32_32x32x16_bf16 v[96:111], v[204:207], v[156:159], v[96:111]
  ds_read_b64_tr_b16 v[176:177], v137 offset:41984
  ds_read_b64_tr_b16 v[178:179], v137 offset:42240
  s_add_u32 m0, s73, 8192
  s_add_u32 s88, s71, 5
  s_and_b32 s88, s88, 7
  s_lshl_b32 s88, s88, 7
  s_add_u32 s88, s88, s72
  buffer_load_dwordx4 v132, s[4:7], s88 offen lds
  ds_read_b64_tr_b16 a[148:149], v220 offset:36864
  ds_read_b64_tr_b16 a[150:151], v220 offset:37376
  s_waitcnt lgkmcnt(10)
  v_mfma_f32_32x32x16_bf16 v[112:127], v[204:207], v[160:163], v[112:127]
  ds_read_b64_tr_b16 v[180:181], v137 offset:39936
  ds_read_b64_tr_b16 v[182:183], v137 offset:40192
  ds_read_b64_tr_b16 a[152:153], v220 offset:37888
  ds_read_b64_tr_b16 a[154:155], v220 offset:38400
  s_waitcnt lgkmcnt(12)
  v_mfma_f32_32x32x16_bf16 v[80:95], v[164:167], v[204:207], v[80:95]
  ds_read_b64_tr_b16 v[184:185], v139 offset:39936
  ds_read_b64_tr_b16 v[186:187], v139 offset:40192
  s_add_u32 m0, s73, 9216
  s_add_u32 s88, s88, 8192
  buffer_load_dwordx4 v133, s[4:7], s88 offen lds
  ds_read_b64_tr_b16 a[156:157], v220 offset:38912
  ds_read_b64_tr_b16 a[158:159], v220 offset:39424
  s_waitcnt lgkmcnt(14)
  v_mfma_f32_16x16x32_bf16 v[148:151], v[152:155], v[168:171], v[148:151]
  ds_read_b64_tr_b16 v[156:157], v137 offset:44032
  ds_read_b64_tr_b16 v[158:159], v137 offset:44288
  s_waitcnt lgkmcnt(14)
  v_mfma_f32_32x32x16_bf16 v[96:111], v[208:211], v[172:175], v[96:111]
  ds_read_b64_tr_b16 v[160:161], v137 offset:45056
  ds_read_b64_tr_b16 v[162:163], v137 offset:45312
  s_add_u32 m0, s73, 10240
  s_add_u32 s88, s88, 8192
  buffer_load_dwordx4 v132, s[4:7], s88 offen lds
  s_waitcnt lgkmcnt(14)
  v_mfma_f32_32x32x16_bf16 v[112:127], v[208:211], v[176:179], v[112:127]
  ds_read_b64_tr_b16 v[164:165], v137 offset:43008
  ds_read_b64_tr_b16 v[166:167], v137 offset:43264
  s_add_u32 m0, s73, 11264
  s_add_u32 s88, s88, 8192
  buffer_load_dwordx4 v133, s[4:7], s88 offen lds
  s_waitcnt lgkmcnt(12)
  v_mfma_f32_32x32x16_bf16 v[80:95], v[180:183], v[208:211], v[80:95]
  ds_read_b64_tr_b16 v[168:169], v139 offset:43008
  ds_read_b64_tr_b16 v[170:171], v139 offset:43264
  s_waitcnt lgkmcnt(10)
  v_mfma_f32_16x16x32_bf16 v[148:151], v[152:155], v[184:187], v[148:151]
  ds_read_b64_tr_b16 v[172:173], v137 offset:47104
  ds_read_b64_tr_b16 v[174:175], v137 offset:47360
  s_add_u32 m0, s75, 73728
  s_add_u32 s89, s71, 6
  s_and_b32 s89, s89, 7
  s_mul_i32 s89, s89, 196608
  s_add_u32 s89, s89, s74
  buffer_load_dwordx4 v134, s[8:11], s89 offen offset:1024 lds
  s_waitcnt lgkmcnt(8)
  v_mfma_f32_32x32x16_bf16 v[96:111], v[212:215], v[156:159], v[96:111]
  ds_read_b64_tr_b16 v[176:177], v137 offset:48128
  ds_read_b64_tr_b16 v[178:179], v137 offset:48384
  s_waitcnt lgkmcnt(8)
  v_mfma_f32_32x32x16_bf16 v[112:127], v[212:215], v[160:163], v[112:127]
  ds_read_b64_tr_b16 v[180:181], v137 offset:46080
  ds_read_b64_tr_b16 v[182:183], v137 offset:46336
  s_waitcnt lgkmcnt(8)
  v_mfma_f32_32x32x16_bf16 v[80:95], v[164:167], v[212:215], v[80:95]
  ds_read_b64_tr_b16 v[184:185], v139 offset:46080
  ds_read_b64_tr_b16 v[186:187], v139 offset:46336
  s_add_u32 m0, s75, 73728
  s_nop 0
  buffer_load_dwordx4 v134, s[8:11], s89 offen offset:2048 lds
  s_waitcnt lgkmcnt(8)
  v_mfma_f32_16x16x32_bf16 v[148:151], v[152:155], v[168:171], v[148:151]
  s_waitcnt vmcnt(16)
  s_barrier
  s_cmp_lg_u32 s78, 4
  s_cbranch_scc1 L10
  s_nop 0
  ds_read_b64 v[240:241], v74 offset:4096
  ds_read_b64 v[242:243], v75 offset:4096
  ds_read_b64 v[244:245], v76 offset:4096
  ds_read_b64 v[246:247], v77 offset:4096
L10:
  ds_read_b128 v[188:191], v128 offset:4096
  ds_read_b128 v[192:195], v129 offset:4096
  ds_read_b128 v[196:199], v130 offset:4096
  ds_read_b128 v[200:203], v131 offset:4096
  ds_read_b64_tr_b16 v[156:157], v138 offset:1024
  ds_read_b64_tr_b16 v[158:159], v138 offset:1280
  s_waitcnt lgkmcnt(12)
  v_mfma_f32_32x32x16_bf16 v[96:111], v[216:219], v[172:175], v[96:111]
  ds_read_b64_tr_b16 v[160:161], v138 offset:2048
  ds_read_b64_tr_b16 v[162:163], v138 offset:2304
  s_waitcnt lgkmcnt(12)
  v_mfma_f32_32x32x16_bf16 v[112:127], v[216:219], v[176:179], v[112:127]
  ds_read_b64_tr_b16 v[164:165], v138 offset:0
  ds_read_b64_tr_b16 v[166:167], v138 offset:256
  s_add_u32 m0, s75, 73728
  s_xor_b32 s89, s89, 512
  buffer_load_dwordx4 v134, s[8:11], s89 offen offset:0 lds
  s_waitcnt lgkmcnt(12)
  v_mfma_f32_32x32x16_bf16 v[80:95], v[180:183], v[216:219], v[80:95]
  ds_read_b64_tr_b16 v[168:169], v140 offset:0
  ds_read_b64_tr_b16 v[170:171], v140 offset:256
  s_waitcnt lgkmcnt(12)
  v_mfma_f32_16x16x32_bf16 v[148:151], v[152:155], v[184:187], v[148:151]
  ds_read_b64_tr_b16 v[172:173], v138 offset:4096
  ds_read_b64_tr_b16 v[174:175], v138 offset:4352
  s_waitcnt lgkmcnt(8)
  v_mfma_f32_32x32x16_bf16 v[96:111], v[188:191], v[156:159], v[96:111]
  ds_read_b64_tr_b16 v[176:177], v138 offset:5120
  ds_read_b64_tr_b16 v[178:179], v138 offset:5376
  s_add_u32 m0, s73, 0
  s_add_u32 s88, s71, 6
  s_and_b32 s88, s88, 7
  s_lshl_b32 s88, s88, 7
  s_add_u32 s88, s88, s72
  buffer_load_dwordx4 v132, s[4:7], s88 offen lds
  ds_read_b64_tr_b16 a[160:161], v221 offset:0
  ds_read_b64_tr_b16 a[162:163], v221 offset:512
  s_waitcnt lgkmcnt(10)
  v_mfma_f32_32x32x16_bf16 v[112:127], v[188:191], v[160:163], v[112:127]
  ds_read_b64_tr_b16 v[180:181], v138 offset:3072
  ds_read_b64_tr_b16 v[182:183], v138 offset:3328
  ds_read_b64_tr_b16 a[164:165], v221 offset:1024
  ds_read_b64_tr_b16 a[166:167], v221 offset:1536
  s_waitcnt lgkmcnt(12)
  v_mfma_f32_32x32x16_bf16 v[80:95], v[164:167], v[188:191], v[80:95]
  ds_read_b64_tr_b16 v[184:185], v140 offset:3072
  ds_read_b64_tr_b16 v[186:187], v140 offset:3328
  s_add_u32 m0, s73, 1024
  s_add_u32 s88, s88, 8192
  buffer_load_dwordx4 v133, s[4:7], s88 offen lds
  ds_read_b64_tr_b16 a[168:169], v221 offset:2048
  ds_read_b64_tr_b16 a[170:171], v221 offset:2560
  s_waitcnt lgkmcnt(14)
  v_mfma_f32_16x16x32_bf16 v[148:151], v[152:155], v[168:171], v[148:151]
  ds_read_b64_tr_b16 v[156:157], v138 offset:7168
  ds_read_b64_tr_b16 v[158:159], v138 offset:7424
  s_waitcnt vmcnt(12)
  s_waitcnt lgkmcnt(14)
  v_mfma_f32_32x32x16_bf16 v[96:111], v[192:195], v[172:175], v[96:111]
  s_nop 0
  ds_read_b64_tr_b16 v[160:161], v138 offset:8192
  ds_read_b64_tr_b16 v[162:163], v138 offset:8448
  s_add_u32 m0, s73, 2048
  s_add_u32 s88, s88, 8192
  buffer_load_dwordx4 v132, s[4:7], s88 offen lds
  ds_read_b64_tr_b16 v[48:49], v144 offset:0
  ds_read_b64_tr_b16 v[50:51], v144 offset:1024
  s_waitcnt lgkmcnt(15)
  v_mfma_f32_32x32x16_bf16 v[112:127], v[192:195], v[176:179], v[112:127]
  s_nop 0
  ds_read_b64_tr_b16 v[164:165], v138 offset:6144
  ds_read_b64_tr_b16 v[166:167], v138 offset:6400
  s_add_u32 m0, s73, 3072
  s_add_u32 s88, s88, 8192
  buffer_load_dwordx4 v133, s[4:7], s88 offen lds
  ds_read_b64_tr_b16 v[52:53], v145 offset:0
  ds_read_b64_tr_b16 v[54:55], v145 offset:1024
  s_waitcnt lgkmcnt(15)
  v_mfma_f32_32x32x16_bf16 v[80:95], v[180:183], v[192:195], v[80:95]
  ds_read_b64_tr_b16 v[168:169], v140 offset:6144
  ds_read_b64_tr_b16 v[170:171], v140 offset:6400
  s_waitcnt lgkmcnt(14)
  v_mfma_f32_16x16x32_bf16 v[148:151], v[152:155], v[184:187], v[148:151]
  ds_read_b64_tr_b16 v[172:173], v138 offset:10240
  ds_read_b64_tr_b16 v[174:175], v138 offset:10496
  s_add_u32 m0, s75, 86016
  s_add_u32 s89, s71, 7
  s_and_b32 s89, s89, 7
  s_mul_i32 s89, s89, 196608
  s_add_u32 s89, s89, s74
  buffer_load_dwordx4 v134, s[8:11], s89 offen offset:1024 lds
  s_waitcnt vmcnt(13)
  s_waitcnt lgkmcnt(12)
  v_mfma_f32_32x32x16_bf16 v[96:111], v[196:199], v[156:159], v[96:111]
  ds_read_b64_tr_b16 v[176:177], v138 offset:11264
  ds_read_b64_tr_b16 v[178:179], v138 offset:11520
  ds_read_b64_tr_b16 v[56:57], v144 offset:2048
  ds_read_b64_tr_b16 v[58:59], v144 offset:3072
  s_waitcnt lgkmcnt(14)
  v_mfma_f32_32x32x16_bf16 v[112:127], v[196:199], v[160:163], v[112:127]
  ds_read_b64_tr_b16 v[180:181], v138 offset:9216
  ds_read_b64_tr_b16 v[182:183], v138 offset:9472
  ds_read_b64_tr_b16 v[60:61], v145 offset:2048
  ds_read_b64_tr_b16 v[62:63], v145 offset:3072
  s_waitcnt lgkmcnt(14)
  v_mfma_f32_32x32x16_bf16 v[80:95], v[164:167], v[196:199], v[80:95]
  ds_read_b64_tr_b16 v[184:185], v140 offset:9216
  ds_read_b64_tr_b16 v[186:187], v140 offset:9472
  s_add_u32 m0, s75, 86016
  s_nop 0
  buffer_load_dwordx4 v134, s[8:11], s89 offen offset:2048 lds
  s_waitcnt lgkmcnt(12)
  v_mfma_f32_16x16x32_bf16 v[148:151], v[152:155], v[168:171], v[148:151]
  s_waitcnt vmcnt(9)
  s_barrier
  s_cmp_lg_u32 s78, 5
  s_cbranch_scc1 L11
  s_nop 0
  ds_read_b64 v[240:241], v74 offset:8192
  ds_read_b64 v[242:243], v75 offset:8192
  ds_read_b64 v[244:245], v76 offset:8192
  ds_read_b64 v[246:247], v77 offset:8192
L11:
  ds_read_b128 v[204:207], v128 offset:8192
  ds_read_b128 v[208:211], v129 offset:8192
  ds_read_b128 v[212:215], v130 offset:8192
  ds_read_b128 v[216:219], v131 offset:8192
  ds_read_b64_tr_b16 v[156:157], v138 offset:13312
  ds_read_b64_tr_b16 v[158:159], v138 offset:13568
  s_waitcnt lgkmcnt(15)
  v_mfma_f32_32x32x16_bf16 v[96:111], v[200:203], v[172:175], v[96:111]
  ds_read_b64_tr_b16 v[160:161], v138 offset:14336
  ds_read_b64_tr_b16 v[162:163], v138 offset:14592
  s_waitcnt lgkmcnt(15)
  v_mfma_f32_32x32x16_bf16 v[112:127], v[200:203], v[176:179], v[112:127]
  ds_read_b64_tr_b16 v[164:165], v138 offset:12288
  ds_read_b64_tr_b16 v[166:167], v138 offset:12544
  s_add_u32 m0, s75, 86016
  s_xor_b32 s89, s89, 512
  buffer_load_dwordx4 v134, s[8:11], s89 offen offset:0 lds
  s_waitcnt lgkmcnt(14)
  v_mfma_f32_32x32x16_bf16 v[80:95], v[180:183], v[200:203], v[80:95]
  ds_read_b64_tr_b16 v[168:169], v140 offset:12288
  ds_read_b64_tr_b16 v[170:171], v140 offset:12544
  s_waitcnt lgkmcnt(12)
  v_mfma_f32_16x16x32_bf16 v[148:151], v[152:155], v[184:187], v[148:151]
  ds_read_b64_tr_b16 v[172:173], v138 offset:16384
  ds_read_b64_tr_b16 v[174:175], v138 offset:16640
  s_waitcnt lgkmcnt(8)
  v_mfma_f32_32x32x16_bf16 v[96:111], v[204:207], v[156:159], v[96:111]
  ds_read_b64_tr_b16 v[176:177], v138 offset:17408
  ds_read_b64_tr_b16 v[178:179], v138 offset:17664
  s_add_u32 m0, s73, 4096
  s_add_u32 s88, s71, 7
  s_and_b32 s88, s88, 7
  s_lshl_b32 s88, s88, 7
  s_add_u32 s88, s88, s72
  buffer_load_dwordx4 v132, s[4:7], s88 offen lds
  ds_read_b64_tr_b16 a[172:173], v221 offset:12288
  ds_read_b64_tr_b16 a[174:175], v221 offset:12800
  s_waitcnt lgkmcnt(10)
  v_mfma_f32_32x32x16_bf16 v[112:127], v[204:207], v[160:163], v[112:127]
  ds_read_b64_tr_b16 v[180:181], v138 offset:15360
  ds_read_b64_tr_b16 v[182:183], v138 offset:15616
  ds_read_b64_tr_b16 a[176:177], v221 offset:13312
  ds_read_b64_tr_b16 a[178:179], v221 offset:13824
  s_waitcnt lgkmcnt(12)
  v_mfma_f32_32x32x16_bf16 v[80:95], v[164:167], v[204:207], v[80:95]
  ds_read_b64_tr_b16 v[184:185], v140 offset:15360
  ds_read_b64_tr_b16 v[186:187], v140 offset:15616
  ds_read_b64_tr_b16 a[180:181], v221 offset:14336
  ds_read_b64_tr_b16 a[182:183], v221 offset:14848
  s_waitcnt lgkmcnt(14)
  v_mfma_f32_16x16x32_bf16 v[148:151], v[152:155], v[168:171], v[148:151]
  ds_read_b64_tr_b16 v[156:157], v138 offset:19456
  ds_read_b64_tr_b16 v[158:159], v138 offset:19712
  s_waitcnt lgkmcnt(14)
  v_mfma_f32_32x32x16_bf16 v[96:111], v[208:211], v[172:175], v[96:111]
  ds_read_b64_tr_b16 v[160:161], v138 offset:20480
  ds_read_b64_tr_b16 v[162:163], v138 offset:20736
  s_add_u32 m0, s73, 5120
  s_add_u32 s88, s88, 8192
  buffer_load_dwordx4 v133, s[4:7], s88 offen lds
  s_waitcnt lgkmcnt(14)
  v_mfma_f32_32x32x16_bf16 v[112:127], v[208:211], v[176:179], v[112:127]
  ds_read_b64_tr_b16 v[164:165], v138 offset:18432
  ds_read_b64_tr_b16 v[166:167], v138 offset:18688
  s_waitcnt lgkmcnt(12)
  v_mfma_f32_32x32x16_bf16 v[80:95], v[180:183], v[208:211], v[80:95]
  ds_read_b64_tr_b16 v[168:169], v140 offset:18432
  ds_read_b64_tr_b16 v[170:171], v140 offset:18688
  s_waitcnt lgkmcnt(10)
  v_mfma_f32_16x16x32_bf16 v[148:151], v[152:155], v[184:187], v[148:151]
  ds_read_b64_tr_b16 v[172:173], v138 offset:22528
  ds_read_b64_tr_b16 v[174:175], v138 offset:22784
  s_waitcnt lgkmcnt(8)
  v_mfma_f32_32x32x16_bf16 v[96:111], v[212:215], v[156:159], v[96:111]
  ds_read_b64_tr_b16 v[176:177], v138 offset:23552
  ds_read_b64_tr_b16 v[178:179], v138 offset:23808
  s_add_u32 m0, s73, 6144
  s_add_u32 s88, s88, 8192
  buffer_load_dwordx4 v132, s[4:7], s88 offen lds
  s_waitcnt lgkmcnt(8)
  v_mfma_f32_32x32x16_bf16 v[112:127], v[212:215], v[160:163], v[112:127]
  ds_read_b64_tr_b16 v[180:181], v138 offset:21504
  ds_read_b64_tr_b16 v[182:183], v138 offset:21760
  s_waitcnt lgkmcnt(8)
  v_mfma_f32_32x32x16_bf16 v[80:95], v[164:167], v[212:215], v[80:95]
  ds_read_b64_tr_b16 v[184:185], v140 offset:21504
  ds_read_b64_tr_b16 v[186:187], v140 offset:21760
  s_waitcnt lgkmcnt(8)
  v_mfma_f32_16x16x32_bf16 v[148:151], v[152:155], v[168:171], v[148:151]
  s_waitcnt vmcnt(6)
  s_barrier
  s_cmp_lg_u32 s78, 6
  s_cbranch_scc1 L12
  ds_read_b64 v[240:241], v74 offset:0
  ds_read_b64 v[242:243], v75 offset:0
  ds_read_b64 v[244:245], v76 offset:0
  ds_read_b64 v[246:247], v77 offset:0
L12:
  ds_read_b128 v[188:191], v128 offset:0
  ds_read_b128 v[192:195], v129 offset:0
  ds_read_b128 v[196:199], v130 offset:0
  ds_read_b128 v[200:203], v131 offset:0
  ds_read_b64_tr_b16 v[156:157], v138 offset:25600
  ds_read_b64_tr_b16 v[158:159], v138 offset:25856
  s_waitcnt lgkmcnt(12)
  v_mfma_f32_32x32x16_bf16 v[96:111], v[216:219], v[172:175], v[96:111]
  ds_read_b64_tr_b16 v[160:161], v138 offset:26624
  ds_read_b64_tr_b16 v[162:163], v138 offset:26880
  s_add_u32 m0, s73, 7168
  s_add_u32 s88, s88, 8192
  buffer_load_dwordx4 v133, s[4:7], s88 offen lds
  s_waitcnt lgkmcnt(12)
  v_mfma_f32_32x32x16_bf16 v[112:127], v[216:219], v[176:179], v[112:127]
  ds_read_b64_tr_b16 v[164:165], v138 offset:24576
  ds_read_b64_tr_b16 v[166:167], v138 offset:24832
  s_waitcnt lgkmcnt(12)
  v_mfma_f32_32x32x16_bf16 v[80:95], v[180:183], v[216:219], v[80:95]
  ds_read_b64_tr_b16 v[168:169], v140 offset:24576
  ds_read_b64_tr_b16 v[170:171], v140 offset:24832
  s_waitcnt lgkmcnt(12)
  v_mfma_f32_16x16x32_bf16 v[148:151], v[152:155], v[184:187], v[148:151]
  ds_read_b64_tr_b16 v[172:173], v138 offset:28672
  ds_read_b64_tr_b16 v[174:175], v138 offset:28928
  s_waitcnt lgkmcnt(8)
  v_mfma_f32_32x32x16_bf16 v[96:111], v[188:191], v[156:159], v[96:111]
  ds_read_b64_tr_b16 v[176:177], v138 offset:29696
  ds_read_b64_tr_b16 v[178:179], v138 offset:29952
  s_lshl_b32 s79, s63, 8
  s_add_u32 s79, s79, 344064
  v_and_b32 v255, 0xf8, v27
  buffer_load_dwordx2 v[146:147], v255, s[16:19], s79 offen sc1
  ds_read_b64_tr_b16 a[184:185], v221 offset:24576
  ds_read_b64_tr_b16 a[186:187], v221 offset:25088
  s_waitcnt lgkmcnt(10)
  v_mfma_f32_32x32x16_bf16 v[112:127], v[188:191], v[160:163], v[112:127]
  ds_read_b64_tr_b16 v[180:181], v138 offset:27648
  ds_read_b64_tr_b16 v[182:183], v138 offset:27904
  ds_read_b64_tr_b16 a[188:189], v221 offset:25600
  ds_read_b64_tr_b16 a[190:191], v221 offset:26112
  s_waitcnt lgkmcnt(12)
  v_mfma_f32_32x32x16_bf16 v[80:95], v[164:167], v[188:191], v[80:95]
  ds_read_b64_tr_b16 v[184:185], v140 offset:27648
  ds_read_b64_tr_b16 v[186:187], v140 offset:27904
  buffer_store_dwordx4 v[48:51], v1, s[16:19], s83 offen sc1
  buffer_store_dwordx4 v[52:55], v1, s[16:19], s83 offen offset:1024 sc1
  v_mov_b32 v66, 0x3f803f80
  v_dot2_f32_bf16 v64, v48, v66, 0
  v_dot2_f32_bf16 v65, v52, v66, 0
  v_dot2_f32_bf16 v64, v49, v66, v64
  v_dot2_f32_bf16 v65, v53, v66, v65
  v_dot2_f32_bf16 v64, v50, v66, v64
  v_dot2_f32_bf16 v65, v54, v66, v65
  v_dot2_f32_bf16 v64, v51, v66, v64
  v_dot2_f32_bf16 v65, v55, v66, v65
  s_lshl_b32 s96, s87, 8
  s_add_u32 s96, s96, 786432
  s_cmp_lt_u32 s87, 896
  s_cselect_b32 s96, s96, s18
  v_permlane32_swap_b32 v64, v65
  v_add_f32 v64, v64, v65
  buffer_store_dword v64, v28, s[16:19], s96 offen sc1
  ds_read_b64_tr_b16 a[192:193], v221 offset:26624
  ds_read_b64_tr_b16 a[194:195], v221 offset:27136
  s_waitcnt lgkmcnt(14)
  v_mfma_f32_16x16x32_bf16 v[148:151], v[152:155], v[168:171], v[148:151]
  ds_read_b64_tr_b16 v[156:157], v138 offset:31744
  ds_read_b64_tr_b16 v[158:159], v138 offset:32000
  buffer_store_dwordx4 v[56:59], v1, s[16:19], s84 offen sc1
  buffer_store_dwordx4 v[60:63], v1, s[16:19], s84 offen offset:1024 sc1
  s_waitcnt lgkmcnt(14)
  v_mfma_f32_32x32x16_bf16 v[96:111], v[192:195], v[172:175], v[96:111]
  ds_read_b64_tr_b16 v[160:161], v138 offset:32768
  ds_read_b64_tr_b16 v[162:163], v138 offset:33024
  s_waitcnt lgkmcnt(14)
  v_mfma_f32_32x32x16_bf16 v[112:127], v[192:195], v[176:179], v[112:127]
  ds_read_b64_tr_b16 v[164:165], v138 offset:30720
  ds_read_b64_tr_b16 v[166:167], v138 offset:30976
  v_mov_b32 v224, -1
  v_mov_b32 v225, -1
  s_and_b32 s96, s32, 1
  s_mul_i32 s96, s96, 64
  s_add_u32 s96, s96, s70
  s_add_u32 s96, s96, 393216
  s_mov_b32 exec_hi, 0xff
  buffer_store_dwordx2 v[224:225], v27, s[16:19], s96 offen sc1
  s_mov_b64 exec, -1
  s_waitcnt lgkmcnt(12)
  v_mfma_f32_32x32x16_bf16 v[80:95], v[180:183], v[192:195], v[80:95]
  ds_read_b64_tr_b16 v[168:169], v140 offset:30720
  ds_read_b64_tr_b16 v[170:171], v140 offset:30976
  s_mov_b32 s24, s98
  s_mov_b32 s25, s99
  s_mov_b32 s26, 524288
  s_lshl_b32 s96, s39, 7
  s_lshl_b32 s64, s32, 17
  s_add_u32 s64, s64, s96
  s_lshl_b32 s100, s38, 2
  s_add_u32 s100, s100, s32
  s_mul_i32 s65, s100, 196608
  s_add_u32 s65, s65, s96
  s_lshl_b32 s100, s100, 15
  s_add_u32 s100, s100, s96
  s_lshl_b32 s101, s32, 11
  s_add_u32 m0, s101, 0
  s_add_u32 s96, s64, 0
  buffer_load_dwordx4 v8, s[24:27], s96 offen lds
  s_waitcnt lgkmcnt(10)
  v_mfma_f32_16x16x32_bf16 v[148:151], v[152:155], v[184:187], v[148:151]
  ds_read_b64_tr_b16 v[172:173], v138 offset:34816
  ds_read_b64_tr_b16 v[174:175], v138 offset:35072
  s_waitcnt lgkmcnt(8)
  v_mfma_f32_32x32x16_bf16 v[96:111], v[196:199], v[156:159], v[96:111]
  ds_read_b64_tr_b16 v[176:177], v138 offset:35840
  ds_read_b64_tr_b16 v[178:179], v138 offset:36096
  s_add_u32 m0, s101, 1024
  s_add_u32 s96, s64, 8192
  buffer_load_dwordx4 v8, s[24:27], s96 offen lds
  s_waitcnt vmcnt(8)
  s_mov_b32 s44, 0
L13:
  v_max_u32 v30, v146, v147
  v_cmp_eq_u32_e64 vcc, -1, v30
  s_cbranch_vccz L14
  s_sleep 2
  buffer_load_dwordx2 v[146:147], v255, s[16:19], s79 offen sc1
  s_add_u32 s44, s44, 1
  s_cmp_gt_u32 s44, 200000
  s_cbranch_scc1 Lend
  s_waitcnt vmcnt(0)
  s_branch L13
L14:
  v_mul_f32 v248, 0x3b000000, v146
  s_waitcnt lgkmcnt(8)
  v_mfma_f32_32x32x16_bf16 v[112:127], v[196:199], v[160:163], v[112:127]
  s_nop 0
  ds_read_b64_tr_b16 v[180:181], v138 offset:33792
  ds_read_b64_tr_b16 v[182:183], v138 offset:34048
  s_add_u32 m0, s101, 8192
  s_add_u32 s96, s64, 16384
  buffer_load_dwordx4 v8, s[24:27], s96 offen lds
  v_mul_f32 v250, 0x3b000000, v147
  v_fma_f32 v250, -v248, v248, v250
  s_waitcnt lgkmcnt(8)
  v_mfma_f32_32x32x16_bf16 v[80:95], v[164:167], v[196:199], v[80:95]
  ds_read_b64_tr_b16 v[184:185], v140 offset:33792
  ds_read_b64_tr_b16 v[186:187], v140 offset:34048
  v_max_f32 v250, 0, v250
  v_add_f32 v250, 0x3727c5ac, v250
  s_waitcnt lgkmcnt(8)
  v_mfma_f32_16x16x32_bf16 v[148:151], v[152:155], v[168:171], v[148:151]
  s_barrier
  s_cmp_lg_u32 s78, 7
  s_cbranch_scc1 L15
  ds_read_b64 v[240:241], v74 offset:4096
  ds_read_b64 v[242:243], v75 offset:4096
  ds_read_b64 v[244:245], v76 offset:4096
  ds_read_b64 v[246:247], v77 offset:4096
L15:
  ds_read_b128 v[204:207], v128 offset:4096
  ds_read_b128 v[208:211], v129 offset:4096
  ds_read_b128 v[212:215], v130 offset:4096
  ds_read_b128 v[216:219], v131 offset:4096
  ds_read_b64_tr_b16 v[156:157], v140 offset:36864
  ds_read_b64_tr_b16 v[158:159], v140 offset:37120
  s_add_u32 m0, s101, 9216
  s_add_u32 s96, s64, 24576
  buffer_load_dwordx4 v8, s[24:27], s96 offen lds
  v_rsq_f32_e64 v250, v250
  v_cvt_pk_bf16_f32 v146, -v248, -v248
  s_waitcnt lgkmcnt(12)
  v_mfma_f32_32x32x16_bf16 v[96:111], v[200:203], v[172:175], v[96:111]
  s_nop 0
  ds_read_b64_tr_b16 v[160:161], v140 offset:39936
  ds_read_b64_tr_b16 v[162:163], v140 offset:40192
  s_add_u32 m0, s101, 16384
  s_add_u32 s96, s64, 32768
  buffer_load_dwordx4 v8, s[24:27], s96 offen lds
  v_and_b32 v147, 0xffff0000, v146
  v_add_f32 v147, v248, v147
  s_waitcnt lgkmcnt(12)
  v_mfma_f32_32x32x16_bf16 v[112:127], v[200:203], v[176:179], v[112:127]
  ds_read_b64_tr_b16 v[164:165], v140 offset:43008
  ds_read_b64_tr_b16 v[166:167], v140 offset:43264
  v_cvt_pk_bf16_f32 v147, -v147, -v248
  v_cndmask_b32 v252, 0, v146, s[52:53]
  s_waitcnt lgkmcnt(12)
  v_mfma_f32_32x32x16_bf16 v[80:95], v[180:183], v[200:203], v[80:95]
  s_nop 0
  ds_read_b64_tr_b16 v[168:169], v140 offset:46080
  ds_read_b64_tr_b16 v[170:171], v140 offset:46336
  s_add_u32 m0, s101, 17408
  s_add_u32 s96, s64, 40960
  buffer_load_dwordx4 v8, s[24:27], s96 offen lds
  v_cndmask_b32 v253, 0, v147, s[52:53]
  v_mov_b32 v254, 0
  s_waitcnt lgkmcnt(12)
  v_mfma_f32_16x16x32_bf16 v[148:151], v[152:155], v[184:187], v[148:151]
  ds_read_b64_tr_b16 v[172:173], v138 offset:37888
  ds_read_b64_tr_b16 v[174:175], v138 offset:38144
  s_add_u32 s96, s62, 1572864
  s_mov_b64 exec, 15
  buffer_load_dword v73, v143, s[16:19], s96 offen
  s_mov_b64 exec, -1
  v_mov_b32_e64 v255, 0
  ds_write_b32 v24, v250 offset:2048
  s_waitcnt lgkmcnt(9)
  v_mfma_f32_16x16x32_bf16 v[148:151], v[152:155], v[156:159], v[148:151]
  s_nop 0
  ds_read_b64_tr_b16 v[176:177], v138 offset:40960
  ds_read_b64_tr_b16 v[178:179], v138 offset:41216
  s_add_u32 m0, s101, 24576
  s_add_u32 s96, s64, 49152
  buffer_load_dwordx4 v8, s[24:27], s96 offen lds
  ds_read_b128 v[224:227], v23 offset:2048
  ds_read_b128 v[228:231], v23 offset:2080
  s_waitcnt lgkmcnt(11)
  v_mfma_f32_16x16x32_bf16 v[148:151], v[152:155], v[160:163], v[148:151]
  ds_read_b64_tr_b16 v[180:181], v138 offset:44032
  ds_read_b64_tr_b16 v[182:183], v138 offset:44288
  ds_read_b128 v[232:235], v23 offset:2112
  ds_read_b128 v[236:239], v23 offset:2144
  s_waitcnt lgkmcnt(13)
  v_mfma_f32_16x16x32_bf16 v[148:151], v[152:155], v[164:167], v[148:151]
  ds_read_b64_tr_b16 v[184:185], v138 offset:47104
  ds_read_b64_tr_b16 v[186:187], v138 offset:47360
  ds_read_b64_tr_b16 a[196:197], v221 offset:36864
  ds_read_b64_tr_b16 a[198:199], v221 offset:37376
  s_waitcnt lgkmcnt(15)
  v_mfma_f32_16x16x32_bf16 v[148:151], v[152:155], v[168:171], v[148:151]
  ds_read_b64_tr_b16 v[156:157], v138 offset:38912
  ds_read_b64_tr_b16 v[158:159], v138 offset:39168
  ds_read_b64_tr_b16 a[200:201], v221 offset:37888
  ds_read_b64_tr_b16 a[202:203], v221 offset:38400
  s_waitcnt lgkmcnt(15)
  v_mfma_f32_32x32x16_bf16 v[96:111], v[204:207], v[172:175], v[96:111]
  ds_read_b64_tr_b16 v[160:161], v138 offset:41984
  ds_read_b64_tr_b16 v[162:163], v138 offset:42240
  ds_read_b64_tr_b16 a[204:205], v221 offset:38912
  ds_read_b64_tr_b16 a[206:207], v221 offset:39424
  s_waitcnt lgkmcnt(15)
  v_mfma_f32_32x32x16_bf16 v[96:111], v[208:211], v[176:179], v[96:111]
  ds_read_b64_tr_b16 v[164:165], v138 offset:45056
  ds_read_b64_tr_b16 v[166:167], v138 offset:45312
  s_waitcnt lgkmcnt(15)
  v_mfma_f32_32x32x16_bf16 v[96:111], v[212:215], v[180:183], v[96:111]
  ds_read_b64_tr_b16 v[168:169], v138 offset:48128
  ds_read_b64_tr_b16 v[170:171], v138 offset:48384
  s_waitcnt lgkmcnt(14)
  v_mfma_f32_32x32x16_bf16 v[96:111], v[216:219], v[184:187], v[96:111]
  v_cndmask_b32 v190, v148, v149, s[58:59]
  v_cvt_pk_bf16_f32 v189, v190, 0
  v_lshlrev_b32 v191, 16, v189
  v_sub_f32_e64 v191, v190, v191
  v_cvt_pk_bf16_f32 v188, v190, v191
  v_and_b32 v189, 0xffff0000, v188
  v_sub_f32_e64 v191, v191, v189
  v_cvt_pk_bf16_f32 v189, v190, v191
  s_lshl_b32 s96, s76, 8
  v_add_u32 v190, s96, v16
  ds_write_b64 v190, v[188:189] offset:0
  s_waitcnt lgkmcnt(0)
  s_barrier
  ds_read_b64 v[172:173], v16 offset:256
  v_mfma_f32_32x32x16_bf16 v[112:127], v[204:207], v[156:159], v[112:127]
  ds_read_b64 v[176:177], v16 offset:512
  s_add_u32 m0, s101, 25600
  s_add_u32 s96, s64, 57344
  buffer_load_dwordx4 v8, s[24:27], s96 offen lds
  v_mfma_f32_32x32x16_bf16 v[112:127], v[208:211], v[160:163], v[112:127]
  ds_read_b64_tr_b16 v[180:181], v138 offset:36864
  ds_read_b64_tr_b16 v[182:183], v138 offset:37120
  v_mfma_f32_32x32x16_bf16 v[112:127], v[212:215], v[164:167], v[112:127]
  ds_read_b64_tr_b16 v[184:185], v138 offset:39936
  ds_read_b64_tr_b16 v[186:187], v138 offset:40192
  v_mfma_f32_32x32x16_bf16 v[112:127], v[216:219], v[168:171], v[112:127]
  ds_read_b64_tr_b16 v[156:157], v138 offset:43008
  ds_read_b64_tr_b16 v[158:159], v138 offset:43264
  s_waitcnt lgkmcnt(7)
  v_mfma_f32_32x32x16_bf16 v[96:111], v[252:255], v[172:175], v[96:111]
  ds_read_b64_tr_b16 v[160:161], v138 offset:46080
  ds_read_b64_tr_b16 v[162:163], v138 offset:46336
  s_waitcnt lgkmcnt(8)
  v_mfma_f32_32x32x16_bf16 v[112:127], v[252:255], v[176:179], v[112:127]
  ds_read_b64 v[164:165], v16 offset:0
  s_waitcnt lgkmcnt(7)
  v_mfma_f32_32x32x16_bf16 v[80:95], v[180:183], v[204:207], v[80:95]
  s_nop 4
  v_pk_fma_f32 v[96:97], v[96:97], v[224:225], s[48:49]
  v_pk_fma_f32 v[98:99], v[98:99], v[226:227], s[48:49]
  v_pk_fma_f32 v[100:101], v[100:101], v[228:229], s[48:49]
  s_waitcnt lgkmcnt(5)
  v_mfma_f32_32x32x16_bf16 v[80:95], v[184:187], v[208:211], v[80:95]
  v_pk_fma_f32 v[102:103], v[102:103], v[230:231], s[48:49]
  v_pk_fma_f32 v[104:105], v[104:105], v[232:233], s[48:49]
  v_pk_fma_f32 v[106:107], v[106:107], v[234:235], s[48:49]
  v_pk_fma_f32 v[108:109], v[108:109], v[236:237], s[48:49]
  s_waitcnt lgkmcnt(3)
  v_mfma_f32_32x32x16_bf16 v[80:95], v[156:159], v[212:215], v[80:95]
  v_pk_fma_f32 v[110:111], v[110:111], v[238:239], s[48:49]
  v_pk_mul_f32 v[188:189], v[96:97], s[50:51]
  v_pk_mul_f32 v[190:191], v[98:99], s[50:51]
  v_pk_mul_f32 v[192:193], v[100:101], s[50:51]
  s_waitcnt lgkmcnt(1)
  v_mfma_f32_32x32x16_bf16 v[80:95], v[160:163], v[216:219], v[80:95]
  v_pk_mul_f32 v[194:195], v[102:103], s[50:51]
  v_pk_mul_f32 v[196:197], v[104:105], s[50:51]
  v_pk_mul_f32 v[198:199], v[106:107], s[50:51]
  v_pk_mul_f32 v[200:201], v[108:109], s[50:51]
  s_waitcnt lgkmcnt(0)
  v_mfma_f32_32x32x16_bf16 v[80:95], v[164:167], v[252:255], v[80:95]
  v_pk_mul_f32 v[202:203], v[110:111], s[50:51]
  v_exp_f32_e64 v188, v188 clamp
  v_max_f32_e64 v96, s48, v96
  v_exp_f32_e64 v189, v189 clamp
  s_add_u32 m0, s101, 32768
  s_add_u32 s96, s64, 65536
  buffer_load_dwordx4 v8, s[24:27], s96 offen lds
  v_max_f32_e64 v97, s48, v97
  v_exp_f32_e64 v190, v190 clamp
  v_max_f32_e64 v98, s48, v98
  v_exp_f32_e64 v191, v191 clamp
  v_max_f32_e64 v99, s48, v99
  v_exp_f32_e64 v192, v192 clamp
  v_max_f32_e64 v100, s48, v100
  v_exp_f32_e64 v193, v193 clamp
  v_max_f32_e64 v101, s48, v101
  v_exp_f32_e64 v194, v194 clamp
  v_max_f32_e64 v102, s48, v102
  v_exp_f32_e64 v195, v195 clamp
  s_add_u32 m0, s101, 33792
  s_add_u32 s96, s64, 73728
  buffer_load_dwordx4 v8, s[24:27], s96 offen lds
  v_max_f32_e64 v103, s48, v103
  v_exp_f32_e64 v196, v196 clamp
  v_max_f32_e64 v104, s48, v104
  v_exp_f32_e64 v197, v197 clamp
  v_max_f32_e64 v105, s48, v105
  v_exp_f32_e64 v198, v198 clamp
  v_max_f32_e64 v106, s48, v106
  v_exp_f32_e64 v199, v199 clamp
  v_max_f32_e64 v107, s48, v107
  v_exp_f32_e64 v200, v200 clamp
  v_max_f32_e64 v108, s48, v108
  v_exp_f32_e64 v201, v201 clamp
  s_add_u32 m0, s101, 40960
  s_add_u32 s96, s64, 81920
  buffer_load_dwordx4 v8, s[24:27], s96 offen lds
  v_max_f32_e64 v109, s48, v109
  v_exp_f32_e64 v202, v202 clamp
  v_max_f32_e64 v110, s48, v110
  v_exp_f32_e64 v203, v203 clamp
  v_max_f32_e64 v111, s48, v111
  v_pk_add_f32 v[96:97], v[96:97], v[188:189]
  v_pk_add_f32 v[98:99], v[98:99], v[190:191]
  v_pk_add_f32 v[100:101], v[100:101], v[192:193]
  v_pk_add_f32 v[102:103], v[102:103], v[194:195]
  v_pk_add_f32 v[104:105], v[104:105], v[196:197]
  v_pk_add_f32 v[106:107], v[106:107], v[198:199]
  v_pk_add_f32 v[108:109], v[108:109], v[200:201]
  s_add_u32 m0, s101, 41984
  s_add_u32 s96, s64, 90112
  buffer_load_dwordx4 v8, s[24:27], s96 offen lds
  v_pk_add_f32 v[110:111], v[110:111], v[202:203]
  v_cvt_pk_bf16_f32 v188, v96, v97
  v_cvt_pk_bf16_f32 v189, v98, v99
  v_cvt_pk_bf16_f32 v190, v100, v101
  v_cvt_pk_bf16_f32 v191, v102, v103
  v_cvt_pk_bf16_f32 v192, v104, v105
  v_cvt_pk_bf16_f32 v193, v106, v107
  v_cvt_pk_bf16_f32 v194, v108, v109
  v_cvt_pk_bf16_f32 v195, v110, v111
  v_pk_add_f32 v[96:97], v[96:97], v[104:105]
  v_pk_add_f32 v[98:99], v[98:99], v[106:107]
  v_pk_add_f32 v[100:101], v[100:101], v[108:109]
  s_add_u32 m0, s101, 49152
  s_add_u32 s96, s64, 98304
  buffer_load_dwordx4 v8, s[24:27], s96 offen lds
  v_pk_add_f32 v[102:103], v[102:103], v[110:111]
  v_pk_add_f32 v[96:97], v[96:97], v[100:101]
  v_pk_add_f32 v[98:99], v[98:99], v[102:103]
  v_pk_mul_f32 v[112:113], v[112:113], v[224:225]
  v_pk_mul_f32 v[114:115], v[114:115], v[226:227]
  v_pk_mul_f32 v[116:117], v[116:117], v[228:229]
  v_pk_mul_f32 v[118:119], v[118:119], v[230:231]
  v_pk_mul_f32 v[120:121], v[120:121], v[232:233]
  v_pk_mul_f32 v[122:123], v[122:123], v[234:235]
  v_pk_mul_f32 v[124:125], v[124:125], v[236:237]
  v_pk_mul_f32 v[126:127], v[126:127], v[238:239]
  v_cvt_pk_bf16_f32 v196, v112, v113
  s_add_u32 m0, s101, 50176
  s_add_u32 s96, s64, 106496
  buffer_load_dwordx4 v8, s[24:27], s96 offen lds
  v_cvt_pk_bf16_f32 v197, v114, v115
  v_cvt_pk_bf16_f32 v198, v116, v117
  v_cvt_pk_bf16_f32 v199, v118, v119
  v_cvt_pk_bf16_f32 v200, v120, v121
  v_cvt_pk_bf16_f32 v201, v122, v123
  v_cvt_pk_bf16_f32 v202, v124, v125
  v_cvt_pk_bf16_f32 v203, v126, v127
  v_pk_add_f32 v[96:97], v[96:97], v[98:99]
  v_add_f32_e64 v104, v96, v97
  v_mfma_f32_32x32x16_bf16 v[112:127], v[188:191], v[196:199], 0
  v_mfma_f32_32x32x16_bf16 v[112:127], v[192:195], v[200:203], v[112:127]
  v_mov_b32 v105, v104
  s_add_u32 s72, s70, 0
  v_pk_fma_f32 v[80:81], v[80:81], v[250:251], s[48:49] op_sel_hi:[1,0,1]
  v_pk_fma_f32 v[82:83], v[82:83], v[250:251], s[48:49] op_sel_hi:[1,0,1]
  v_permlane32_swap_b32 v104, v105
  v_add_f32 v104, v104, v105
  ds_write_b32 v22, v104
  v_pk_fma_f32 v[84:85], v[84:85], v[250:251], s[48:49] op_sel_hi:[1,0,1]
  v_pk_fma_f32 v[86:87], v[86:87], v[250:251], s[48:49] op_sel_hi:[1,0,1]
  v_pk_fma_f32 v[88:89], v[88:89], v[250:251], s[48:49] op_sel_hi:[1,0,1]
  v_pk_fma_f32 v[90:91], v[90:91], v[250:251], s[48:49] op_sel_hi:[1,0,1]
  v_pk_fma_f32 v[92:93], v[92:93], v[250:251], s[48:49] op_sel_hi:[1,0,1]
  v_cndmask_b32 v112, v112, v120, s[58:59]
  v_cndmask_b32 v113, v113, v121, s[58:59]
  v_cndmask_b32 v114, v114, v122, s[58:59]
  v_cndmask_b32 v115, v115, v123, s[58:59]
  ds_write_b128 v21, v[112:115] offset:0
  v_cndmask_b32 v116, v116, v124, s[58:59]
  v_cndmask_b32 v117, v117, v125, s[58:59]
  v_cndmask_b32 v118, v118, v126, s[58:59]
  v_cndmask_b32 v119, v119, v127, s[58:59]
  ds_write_b128 v21, v[116:119] offset:16
  v_pk_fma_f32 v[94:95], v[94:95], v[250:251], s[48:49] op_sel_hi:[1,0,1]
  v_pk_mul_f32 v[160:161], v[80:81], s[50:51]
  v_pk_mul_f32 v[162:163], v[82:83], s[50:51]
  v_pk_mul_f32 v[164:165], v[84:85], s[50:51]
  v_pk_mul_f32 v[166:167], v[86:87], s[50:51]
  v_pk_mul_f32 v[168:169], v[88:89], s[50:51]
  v_pk_mul_f32 v[170:171], v[90:91], s[50:51]
  v_pk_mul_f32 v[172:173], v[92:93], s[50:51]
  v_pk_mul_f32 v[174:175], v[94:95], s[50:51]
  s_waitcnt vmcnt(15) lgkmcnt(0)
  s_barrier
  ds_read_b128 v[224:227], v26 offset:0
  ds_read_b128 v[228:231], v26 offset:2304
  ds_read_b128 v[232:235], v26 offset:4608
  ds_read_b128 v[236:239], v26 offset:6912
  v_exp_f32_e64 v160, v160 clamp
  v_max_f32_e64 v80, s48, v80
  v_exp_f32_e64 v161, v161 clamp
  v_max_f32_e64 v81, s48, v81
  v_exp_f32_e64 v162, v162 clamp
  v_max_f32_e64 v82, s48, v82
  v_exp_f32_e64 v163, v163 clamp
  v_max_f32_e64 v83, s48, v83
  v_exp_f32_e64 v164, v164 clamp
  v_max_f32_e64 v84, s48, v84
  v_exp_f32_e64 v165, v165 clamp
  v_max_f32_e64 v85, s48, v85
  v_exp_f32_e64 v166, v166 clamp
  v_max_f32_e64 v86, s48, v86
  s_waitcnt lgkmcnt(0)
  s_nop 0
  v_pk_add_f32 v[224:225], v[224:225], v[228:229]
  v_pk_add_f32 v[232:233], v[232:233], v[236:237]
  v_pk_add_f32 v[226:227], v[226:227], v[230:231]
  v_pk_add_f32 v[234:235], v[234:235], v[238:239]
  v_pk_add_f32 v[224:225], v[224:225], v[232:233]
  v_pk_add_f32 v[226:227], v[226:227], v[234:235]
  v_cvt_pk_bf16_f32 v228, v224, v225
  v_cvt_pk_bf16_f32 v229, v226, v227
  v_min_u32 v228, -2, v228
  v_min_u32_e64 v229, -2, v229
  s_mov_b32 exec_hi, s43
  buffer_store_dwordx2 v[228:229], v27, s[16:19], s72 offen sc1
  s_mov_b64 exec, -1
  s_lshl_b32 s93, s33, 7
  s_add_u32 s93, s93, 335872
  v_and_b32 v221, 0x7c, v28
  buffer_load_dword v220, v221, s[16:19], s93 offen sc1
  s_xor_b32 s75, s36, 8
  s_lshr_b32 s77, s32, 1
  s_lshl1_add_u32 s72, s75, s77
  s_mul_i32 s72, s72, 10240
  s_add_u32 s72, s72, 0
  s_and_b32 s79, s32, 1
  s_lshl4_add_u32 s74, s79, s72
  s_lshl_b32 s76, s79, 8
  s_add_u32 s72, s72, s76
  s_add_u32 s73, s72, 5120
  s_movk_i32 s78, 640
  v_lshrrev_b32 v238, 4, v0
  v_and_b32 v239, 0xf0, v1
  v_mad_u32_u24 v235, v238, s78, v239
  v_lshl_add_u32 v234, v238, 2, v239
  v_lshrrev_b32 v238, 2, v0
  v_and_b32 v239, 12, v28
  v_mad_u32_u24 v236, v238, s78, v239
  s_add_u32 m0, s101, 57344
  s_add_u32 s96, s64, 114688
  buffer_load_dwordx4 v8, s[24:27], s96 offen lds
  v_exp_f32_e64 v167, v167 clamp
  v_max_f32_e64 v87, s48, v87
  v_exp_f32_e64 v168, v168 clamp
  v_max_f32_e64 v88, s48, v88
  v_exp_f32_e64 v169, v169 clamp
  v_max_f32_e64 v89, s48, v89
  v_exp_f32_e64 v170, v170 clamp
  s_add_u32 m0, s101, 58368
  s_add_u32 s96, s64, 122880
  buffer_load_dwordx4 v8, s[24:27], s96 offen lds
  v_max_f32_e64 v90, s48, v90
  v_exp_f32_e64 v171, v171 clamp
  v_max_f32_e64 v91, s48, v91
  v_exp_f32_e64 v172, v172 clamp
  v_max_f32_e64 v92, s48, v92
  v_exp_f32_e64 v173, v173 clamp
  v_max_f32_e64 v93, s48, v93
  s_add_u32 m0, s101, 65536
  s_add_u32 s96, s65, 0
  s_nop 0
  buffer_load_dwordx4 v8, s[28:31], s96 offen lds
  v_exp_f32_e64 v174, v174 clamp
  v_max_f32_e64 v94, s48, v94
  v_exp_f32_e64 v175, v175 clamp
  v_max_f32_e64 v95, s48, v95
  v_pk_add_f32 v[80:81], v[80:81], v[160:161]
  v_pk_add_f32 v[82:83], v[82:83], v[162:163]
  v_pk_add_f32 v[84:85], v[84:85], v[164:165]
  s_add_u32 m0, s101, 66560
  s_add_u32 s96, s65, 8192
  buffer_load_dwordx4 v8, s[28:31], s96 offen lds
  v_pk_add_f32 v[86:87], v[86:87], v[166:167]
  v_pk_add_f32 v[88:89], v[88:89], v[168:169]
  v_pk_add_f32 v[90:91], v[90:91], v[170:171]
  v_pk_add_f32 v[92:93], v[92:93], v[172:173]
  v_pk_add_f32 v[94:95], v[94:95], v[174:175]
  v_cvt_pk_bf16_f32 v152, v80, v81
  v_cvt_pk_bf16_f32 v153, v82, v83
  s_add_u32 m0, s101, 73728
  s_add_u32 s96, s65, 16384
  buffer_load_dwordx4 v8, s[28:31], s96 offen lds
  v_cvt_pk_bf16_f32 v154, v84, v85
  v_cvt_pk_bf16_f32 v155, v86, v87
  v_cvt_pk_bf16_f32 v156, v88, v89
  v_cvt_pk_bf16_f32 v157, v90, v91
  v_cvt_pk_bf16_f32 v158, v92, v93
  v_cvt_pk_bf16_f32 v159, v94, v95
  v_lshrrev_b32_e64 v238, 5, v0
  v_lshl_add_u32 v237, v238, 1, v239
  s_mul_i32 s77, s77, 544
  s_add_u32 s77, s77, 160768
  s_add_u32 s76, s76, s77
  v_add_u32 v234, s76, v234
  s_lshl4_add_u32 s77, s79, s77
  v_add_u32_e64 v237, s77, v237
  s_lshl4_add_u32 s78, s63, s75
  s_mul_i32 s78, s78, 7168
  s_add_u32 s78, s78, 8388608
  v_mov_b32 v232, 0x3f80
  v_mov_b32 v233, 1.0
  v_lshlrev_b32 v32, 16, v240
  v_and_b32 v33, 0xffff0000, v240
  v_lshlrev_b32_e64 v34, 16, v241
  v_and_b32 v35, 0xffff0000, v241
  v_lshlrev_b32_e64 v36, 16, v242
  v_and_b32 v37, 0xffff0000, v242
  v_lshlrev_b32_e64 v38, 16, v243
  v_and_b32 v39, 0xffff0000, v243
  v_lshlrev_b32_e64 v40, 16, v244
  v_and_b32 v41, 0xffff0000, v244
  v_lshlrev_b32_e64 v42, 16, v245
  v_and_b32 v43, 0xffff0000, v245
  v_lshlrev_b32_e64 v44, 16, v246
  v_and_b32 v45, 0xffff0000, v246
  v_lshlrev_b32_e64 v46, 16, v247
  v_and_b32 v47, 0xffff0000, v247
  s_lshl_b32 s41, s33, 10
  s_add_u32 s41, s41, 327680
  s_lshl_b32 s90, s35, 4
  s_add_u32 s90, s90, s36
  s_lshl_b32 s90, s90, 2
  s_add_u32 s90, s90, s32
  s_lshl_b32 s90, s90, 2
  s_add_u32 s42, s41, s90
  s_and_b32 s91, s32, 1
  s_lshl_b32 s90, s46, 15
  s_lshl_b32 s92, s39, 12
  s_add_u32 s61, s90, s92
  s_lshl_b32 s92, s91, 11
  s_add_u32 s61, s61, s92
  v_and_b32 v96, 15, v0
  v_lshrrev_b32 v97, 4, v0
  v_and_b32 v98, 31, v0
  v_lshrrev_b32_e64 v99, 5, v0
  v_add_u32 v10, 49152, v1
  s_lshl_b32 s90, s91, 10
  v_add_u32 v5, s90, v1
  v_xor_b32 v6, 1024, v5
  v_and_b32 v104, 1, v97
  v_lshlrev_b32 v103, 4, v96
  v_mul_u32_u24 v102, 57344, v104
  v_add_u32_e64 v102, v102, v103
  v_lshl_add_u32 v9, v99, 9, v102
  v_lshl_add_u32 v102, v104, 9, v103
  v_lshl_add_u32 v11, v99, 3, v102
  v_bfe_u32 v102, v0, 1, 2
  v_lshlrev_b32 v102, 4, v102
  v_and_b32 v103, 1, v0
  v_lshl_add_u32 v102, v103, 2, v102
  s_lshl_b32 s90, s35, 8
  s_lshl_b32 s92, s32, 6
  s_add_u32 s90, s90, s92
  s_lshl_b32 s92, s38, 3
  s_add_u32 s90, s90, s92
  s_xor_b32 s90, s90, 128
  v_add_u32 v4, s90, v102
  v_bfe_u32 v102, v0, 1, 3
  v_lshlrev_b32_e64 v102, 5, v102
  v_lshl_add_u32 v102, v103, 2, v102
  s_lshl_b32 s90, s35, 8
  s_lshr_b32 s92, s32, 1
  s_lshl_b32 s92, s92, 4
  s_add_u32 s90, s90, s92
  s_lshl_b32 s92, s91, 3
  s_add_u32 s90, s90, s92
  v_add_u32 v3, s90, v102
  v_lshlrev_b32 v102, 4, v98
  v_lshl_add_u32 v12, v99, 2, v102
  v_lshl_add_u32 v13, v99, 11, v102
  v_min_u32 v102, 16, v98
  v_lshlrev_b32 v102, 5, v102
  v_lshl_add_u32 v14, v99, 4, v102
  v_add_u32 v14, 160768, v14
  s_xor_b32 s90, s32, 0
  s_lshl_b32 s90, s90, 13
  s_add_u32 s90, s90, 114688
  v_add_u32_e64 v18, s90, v1
  s_xor_b32 s90, s32, 2
  s_lshl_b32 s90, s90, 13
  s_add_u32 s90, s90, 114688
  v_add_u32_e64 v19, s90, v1
  s_xor_b32 s90, s32, 1
  s_lshl_b32 s90, s90, 13
  s_add_u32 s90, s90, 114688
  v_add_u32_e64 v20, s90, v1
  s_xor_b32 s90, s32, 3
  s_lshl_b32 s90, s90, 13
  s_add_u32 s90, s90, 114688
  v_add_u32_e64 v2, s90, v1
  s_and_b32 s90, s46, 3
  s_lshl_b32 s90, s90, 7
  s_add_u32 s90, s90, 147456
  v_lshl_add_u32 v25, v98, 2, s90
  s_lshl_b32 s90, s46, 15
  s_lshl_b32 s92, s39, 7
  s_add_u32 s60, s90, s92
  s_lshl_b32 s92, s91, 6
  s_add_u32 s60, s60, s92
  v_lshlrev_b32 v102, 10, v98
  v_lshl_add_u32 v15, v99, 4, v102
  s_mov_b32 s14, 2097152
  s_mov_b32 s15, 0x20000
  s_getpc_b64 s[82:83]
L16:
  s_lshl2_add_u32 s96, s34, s32
  v_lshl_add_u32 v7, s96, 1, v0
  v_lshlrev_b32_e64 v7, 7, v7
  v_min_u32 v7, Lend-L16, v7
  s_mov_b64 exec, 3
  global_load_dword v7, v7, s[82:83]
  s_mov_b64 exec, -1
  s_add_u32 m0, s101, 74752
  s_add_u32 s96, s65, 24576
  buffer_load_dwordx4 v8, s[28:31], s96 offen lds
  buffer_load_dword v192, v236, s[16:19], s74 offen offset:512 sc1
  buffer_load_dwordx4 v[176:179], v235, s[16:19], s72 offen offset:0 sc1
  buffer_load_dwordx4 v[180:183], v235, s[16:19], s72 offen offset:2560 sc1
  buffer_load_dwordx4 v[184:187], v235, s[16:19], s73 offen offset:0 sc1
  buffer_load_dwordx4 v[188:191], v235, s[16:19], s73 offen offset:2560 sc1
  s_add_u32 m0, s101, 81920
  s_add_u32 s96, s65, 32768
  buffer_load_dwordx4 v8, s[28:31], s96 offen lds
  s_add_u32 m0, s101, 82944
  s_add_u32 s96, s65, 40960
  buffer_load_dwordx4 v8, s[28:31], s96 offen lds
  s_add_u32 m0, s101, 90112
  s_add_u32 s96, s65, 49152
  buffer_load_dwordx4 v8, s[28:31], s96 offen lds
  s_add_u32 m0, s101, 91136
  s_add_u32 s96, s65, 57344
  buffer_load_dwordx4 v8, s[28:31], s96 offen lds
  s_mul_i32 s84, s46, 114688
  s_xor_b32 s85, s46, 1
  s_mul_i32 s85, s85, 114688
  s_mul_i32 s86, s32, 28672
  s_add_u32 s86, s86, 8388608
  s_add_u32 s84, s84, s86
  s_add_u32 s85, s85, s86
  s_add_u32 s80, s61, 0
  s_add_u32 s81, s62, 1572864
  v_mov_b32 v252, 0x3f803f80
  s_add_u32 m0, s101, 98304
  s_add_u32 s96, s65, 65536
  buffer_load_dwordx4 v8, s[28:31], s96 offen lds
  s_add_u32 m0, s101, 99328
  s_add_u32 s96, s65, 73728
  buffer_load_dwordx4 v8, s[28:31], s96 offen lds
  s_add_u32 m0, s101, 106496
  s_add_u32 s96, s65, 81920
  buffer_load_dwordx4 v8, s[28:31], s96 offen lds
  s_add_u32 m0, s101, 107520
  s_add_u32 s96, s65, 90112
  buffer_load_dwordx4 v8, s[28:31], s96 offen lds
  s_waitcnt vmcnt(20)
  s_mov_b32 s44, 0
L17:
  v_cmp_eq_u32_e64 vcc, -1, v220
  s_cbranch_vccz L18
  s_sleep 4
  buffer_load_dword v220, v221, s[16:19], s93 offen sc1
  s_add_u32 s44, s44, 1
  s_cmp_gt_u32 s44, 200000
  s_cbranch_scc1 Lend
  s_waitcnt vmcnt(0)
  s_branch L17
L18:
  v_cmp_ne_u32 vcc, s45, v220
  s_nop 0
  s_cmp_lg_u64 vcc, 0
  s_cselect_b32 s40, 1, 0
  s_mov_b32 s44, 0
L19:
  s_waitcnt vmcnt(12)
  v_lshlrev_b32_e64 v193, 16, v192
  v_and_b32 v194, 0xffff0000, v192
  s_waitcnt vmcnt(11)
  v_dot2_f32_bf16 v224, v176, v232, 0
  v_dot2_f32_bf16 v225, v176, v233, 0
  v_dot2_f32_bf16 v226, v177, v232, 0
  v_dot2_f32_bf16 v227, v177, v233, 0
  v_max3_u32 v30, v176, v177, v192
  v_permlane32_swap_b32 v193, v194
  v_dot2_f32_bf16 v228, v178, v232, 0
  v_dot2_f32_bf16 v229, v178, v233, 0
  v_dot2_f32_bf16 v230, v179, v232, 0
  v_dot2_f32_bf16 v231, v179, v233, 0
  v_max3_u32 v30, v178, v179, v30
  v_add_f32 v193, v193, v194
  s_waitcnt vmcnt(10)
  v_dot2_f32_bf16 v224, v180, v232, v224
  v_dot2_f32_bf16 v225, v180, v233, v225
  v_dot2_f32_bf16 v226, v181, v232, v226
  v_dot2_f32_bf16 v227, v181, v233, v227
  v_max3_u32 v30, v180, v181, v30
  v_add_f32_dpp v193, v193, v193 row_ror:4 row_mask:0xf bank_mask:0xf
  v_dot2_f32_bf16 v228, v182, v232, v228
  v_dot2_f32_bf16 v229, v182, v233, v229
  v_dot2_f32_bf16 v230, v183, v232, v230
  v_dot2_f32_bf16 v231, v183, v233, v231
  v_max3_u32 v30, v182, v183, v30
  v_add_f32_dpp v193, v193, v193 row_ror:8 row_mask:0xf bank_mask:0xf
  s_waitcnt vmcnt(9)
  v_dot2_f32_bf16 v224, v184, v232, v224
  v_dot2_f32_bf16 v225, v184, v233, v225
  v_dot2_f32_bf16 v226, v185, v232, v226
  v_dot2_f32_bf16 v227, v185, v233, v227
  v_max3_u32 v30, v184, v185, v30
  v_mov_b32 v194, v193
  v_dot2_f32_bf16 v228, v186, v232, v228
  v_dot2_f32_bf16 v229, v186, v233, v229
  v_dot2_f32_bf16 v230, v187, v232, v230
  v_dot2_f32_bf16 v231, v187, v233, v231
  v_max3_u32 v30, v186, v187, v30
  v_permlane16_swap_b32 v193, v194
  s_waitcnt vmcnt(8)
  v_dot2_f32_bf16 v224, v188, v232, v224
  v_dot2_f32_bf16 v225, v188, v233, v225
  v_dot2_f32_bf16 v226, v189, v232, v226
  v_dot2_f32_bf16 v227, v189, v233, v227
  v_max3_u32 v30, v188, v189, v30
  v_add_f32_e64 v193, v193, v194
  v_dot2_f32_bf16 v228, v190, v232, v228
  v_dot2_f32_bf16 v229, v190, v233, v229
  v_dot2_f32_bf16 v230, v191, v232, v230
  v_dot2_f32_bf16 v231, v191, v233, v231
  v_max3_u32 v30, v190, v191, v30
  v_cvt_pk_bf16_f32 v193, v193, v193
  v_cmp_eq_u32 vcc, -1, v30
  s_cbranch_vccnz L20
  ds_write_b16 v237, v193 offset:512
  v_permlane32_swap_b32 v224, v228
  v_permlane32_swap_b32 v225, v229
  v_permlane32_swap_b32 v226, v230
  v_permlane32_swap_b32 v227, v231
  v_pk_add_f32 v[224:225], v[224:225], v[228:229]
  v_pk_add_f32 v[226:227], v[226:227], v[230:231]
  s_nop 1
  v_permlane16_swap_b32 v224, v226
  v_permlane16_swap_b32_e64 v225, v227
  v_pk_add_f32 v[224:225], v[224:225], v[226:227]
  v_cvt_pk_bf16_f32 v224, v224, v225
  ds_write_b32 v234, v224
  s_waitcnt lgkmcnt(0)
  s_barrier
  ds_read_b128 v[160:163], v14 offset:0
  ds_read_b128 v[164:167], v14 offset:544
  s_waitcnt lgkmcnt(1)
  v_mfma_f32_32x32x16_bf16 v[80:95], v[160:163], v[152:155], 0
  s_waitcnt lgkmcnt(0)
  v_mfma_f32_32x32x16_bf16 v[96:111], v[164:167], v[156:159], 0
  s_nop 9
  v_add_f32 v88, s48, v88
  v_rcp_f32 v88, v88
  s_nop 0
  v_pk_mul_f32 v[80:81], v[80:81], v[88:89] op_sel_hi:[1,0]
  v_pk_mul_f32 v[82:83], v[82:83], v[88:89] op_sel_hi:[1,0]
  v_pk_mul_f32 v[84:85], v[84:85], v[88:89] op_sel_hi:[1,0]
  v_pk_mul_f32 v[86:87], v[86:87], v[88:89] op_sel_hi:[1,0]
  v_cvt_pk_bf16_f32 v92, v80, v81
  v_cvt_pk_bf16_f32 v93, v82, v83
  v_cvt_pk_bf16_f32 v94, v84, v85
  v_cvt_pk_bf16_f32 v95, v86, v87
  buffer_store_dwordx4 v[92:95], v1, s[16:19], s78 offen offset:0 sc1
  v_add_f32 v104, s48, v104
  v_rcp_f32_e64 v104, v104
  s_nop 0
  v_pk_mul_f32 v[96:97], v[96:97], v[104:105] op_sel_hi:[1,0]
  v_pk_mul_f32 v[98:99], v[98:99], v[104:105] op_sel_hi:[1,0]
  v_pk_mul_f32 v[100:101], v[100:101], v[104:105] op_sel_hi:[1,0]
  v_pk_mul_f32 v[102:103], v[102:103], v[104:105] op_sel_hi:[1,0]
  v_cvt_pk_bf16_f32 v108, v96, v97
  v_cvt_pk_bf16_f32 v109, v98, v99
  v_cvt_pk_bf16_f32 v110, v100, v101
  v_cvt_pk_bf16_f32 v111, v102, v103
  buffer_store_dwordx4 v[108:111], v1, s[16:19], s78 offen offset:1024 sc1
  s_add_u32 m0, s101, 114688
  s_add_u32 s96, s100, 1572864
  buffer_load_dwordx4 v8, s[28:31], s96 offen lds
  s_add_u32 m0, s101, 115712
  s_add_u32 s96, s100, 1581056
  buffer_load_dwordx4 v8, s[28:31], s96 offen lds
  s_add_u32 m0, s101, 122880
  s_add_u32 s96, s65, 98304
  buffer_load_dwordx4 v8, s[28:31], s96 offen lds
  s_add_u32 m0, s101, 123904
  s_add_u32 s96, s65, 106496
  buffer_load_dwordx4 v8, s[28:31], s96 offen lds
  v_add_u32 v240, 0, v17
  v_xor_b32 v241, 64, v240
  v_add_u32 v242, 65536, v17
  v_xor_b32_e64 v243, 64, v242
  v_add_u32 v244, 131072, v17
  v_xor_b32_e64 v245, 64, v244
  ds_read_b64_tr_b16 a[224:225], v240 offset:0
  ds_read_b64_tr_b16 a[226:227], v240 offset:1024
  ds_read_b64_tr_b16 a[228:229], v241 offset:0
  ds_read_b64_tr_b16 a[230:231], v241 offset:1024
  ds_read_b64_tr_b16 a[232:233], v240 offset:8192
  ds_read_b64_tr_b16 a[234:235], v240 offset:9216
  ds_read_b64_tr_b16 a[236:237], v241 offset:8192
  ds_read_b64_tr_b16 a[238:239], v241 offset:9216
  ds_read_b64_tr_b16 a[240:241], v240 offset:16384
  ds_read_b64_tr_b16 a[242:243], v240 offset:17408
  ds_read_b64_tr_b16 a[244:245], v241 offset:16384
  ds_read_b64_tr_b16 a[246:247], v241 offset:17408
  ds_read_b64_tr_b16 a[248:249], v240 offset:24576
  ds_read_b64_tr_b16 a[250:251], v240 offset:25600
  ds_read_b64_tr_b16 a[252:253], v241 offset:24576
  ds_read_b64_tr_b16 a[254:255], v241 offset:25600
  ds_read_b64_tr_b16 v[48:49], v240 offset:32768
  ds_read_b64_tr_b16 v[50:51], v240 offset:33792
  ds_read_b64_tr_b16 v[52:53], v241 offset:32768
  ds_read_b64_tr_b16 v[54:55], v241 offset:33792
  ds_read_b64_tr_b16 v[56:57], v240 offset:40960
  ds_read_b64_tr_b16 v[58:59], v240 offset:41984
  ds_read_b64_tr_b16 v[60:61], v241 offset:40960
  ds_read_b64_tr_b16 v[62:63], v241 offset:41984
  ds_read_b64_tr_b16 v[64:65], v240 offset:49152
  ds_read_b64_tr_b16 v[66:67], v240 offset:50176
  ds_read_b64_tr_b16 v[68:69], v241 offset:49152
  ds_read_b64_tr_b16 v[70:71], v241 offset:50176
  ds_read_b64_tr_b16 v[72:73], v240 offset:57344
  ds_read_b64_tr_b16 v[74:75], v240 offset:58368
  ds_read_b64_tr_b16 v[76:77], v241 offset:57344
  ds_read_b64_tr_b16 v[78:79], v241 offset:58368
  ds_read_b64_tr_b16 a[0:1], v242 offset:0
  ds_read_b64_tr_b16 a[2:3], v242 offset:1024
  ds_read_b64_tr_b16 a[4:5], v243 offset:0
  ds_read_b64_tr_b16 a[6:7], v243 offset:1024
  ds_read_b64_tr_b16 a[8:9], v242 offset:8192
  ds_read_b64_tr_b16 a[10:11], v242 offset:9216
  ds_read_b64_tr_b16 a[12:13], v243 offset:8192
  ds_read_b64_tr_b16 a[14:15], v243 offset:9216
  s_waitcnt vmcnt(12)
  ds_read_b64_tr_b16 a[16:17], v242 offset:16384
  ds_read_b64_tr_b16 a[18:19], v242 offset:17408
  ds_read_b64_tr_b16 a[20:21], v243 offset:16384
  ds_read_b64_tr_b16 a[22:23], v243 offset:17408
  s_waitcnt vmcnt(10)
  ds_read_b64_tr_b16 a[24:25], v242 offset:24576
  ds_read_b64_tr_b16 a[26:27], v242 offset:25600
  ds_read_b64_tr_b16 a[28:29], v243 offset:24576
  ds_read_b64_tr_b16 a[30:31], v243 offset:25600
  s_waitcnt vmcnt(8)
  ds_read_b64_tr_b16 a[32:33], v242 offset:32768
  ds_read_b64_tr_b16 a[34:35], v242 offset:33792
  ds_read_b64_tr_b16 a[36:37], v243 offset:32768
  ds_read_b64_tr_b16 a[38:39], v243 offset:33792
  s_waitcnt vmcnt(6)
  ds_read_b64_tr_b16 a[40:41], v242 offset:40960
  ds_read_b64_tr_b16 a[42:43], v242 offset:41984
  ds_read_b64_tr_b16 a[44:45], v243 offset:40960
  ds_read_b64_tr_b16 a[46:47], v243 offset:41984
  v_mov_b32_e64 v30, 1
  s_mov_b64 exec, 1
  s_cmp_lg_u32 s40, 0
  s_waitcnt vmcnt(4)
  s_cbranch_scc1 L21
  buffer_store_dword v30, off, s[16:19], s42
  s_branch L22
L21:
  buffer_wbl2 sc1
  s_waitcnt vmcnt(0)
  buffer_store_dword v30, off, s[16:19], s42 sc1
L22:
  s_mov_b64 exec, -1
  v_add_u32 v240, 0, v17
  v_xor_b32_e64 v241, 64, v240
  v_add_u32 v242, 65536, v17
  v_xor_b32_e64 v243, 64, v242
  v_add_u32 v244, 131072, v17
  v_xor_b32 v245, 64, v244
  s_waitcnt vmcnt(3)
  ds_read_b64_tr_b16 a[48:49], v242 offset:49152
  ds_read_b64_tr_b16 a[50:51], v242 offset:50176
  ds_read_b64_tr_b16 a[52:53], v243 offset:49152
  ds_read_b64_tr_b16 a[54:55], v243 offset:50176
  s_waitcnt vmcnt(1)
  s_nop 0
  ds_read_b64_tr_b16 a[56:57], v242 offset:57344
  ds_read_b64_tr_b16 a[58:59], v242 offset:58368
  ds_read_b64_tr_b16 a[60:61], v243 offset:57344
  ds_read_b64_tr_b16 a[62:63], v243 offset:58368
  buffer_load_dword v30, v4, s[16:19], s41 offen sc1
  s_mul_i32 s87, s36, 96
  s_lshl_b32 s88, s32, 5
  s_add_u32 s87, s87, s88
  s_lshl4_add_u32 s88, s36, 1536
  s_cmp_eq_u32 s32, 3
  s_cselect_b32 s87, s88, s87
  s_cselect_b32 s88, 15, 31
  s_lshl2_add_u32 s87, s87, 779264
  v_and_b32 v254, s88, v0
  v_lshrrev_b32_e64 v253, 5, v0
  v_mul_u32_u24 v253, 114688, v253
  v_lshl_add_u32 v254, v254, 2, v253
  s_mov_b32 s44, 0
L23:
  buffer_load_dword v7, v4, s[16:19], s41 offen sc1
  s_waitcnt vmcnt(1)
  v_cmp_gt_i32 vcc, 1, v30
  s_cbranch_vccz L24
  buffer_load_dword v30, v4, s[16:19], s41 offen sc1
  s_add_u32 s44, s44, 1
  s_cmp_gt_u32 s44, 200000
  s_cbranch_scc1 Lend
  s_waitcnt vmcnt(1)
  v_cmp_gt_i32_e64 vcc, 1, v7
  s_cbranch_vccnz L23
L24:
  s_cmp_eq_u32 s40, 0
  s_cbranch_scc1 L25
  buffer_inv sc1
  s_waitcnt vmcnt(0)
L25:
  s_nop 0
  buffer_load_dwordx4 v[80:83], v1, s[16:19], s85 offen offset:0 sc1
  buffer_load_dwordx4 v[84:87], v1, s[16:19], s85 offen offset:1024 sc1
  s_add_u32 s85, s85, 7168
  buffer_load_dwordx4 v[88:91], v1, s[16:19], s85 offen offset:0 sc1
  buffer_load_dwordx4 v[92:95], v1, s[16:19], s85 offen offset:1024 sc1
  s_add_u32 s85, s85, 7168
  buffer_load_dwordx4 v[96:99], v1, s[16:19], s85 offen offset:0 sc1
  buffer_load_dwordx4 v[100:103], v1, s[16:19], s85 offen offset:1024 sc1
  s_waitcnt lgkmcnt(0)
  s_barrier
  s_waitcnt vmcnt(5)
  v_mfma_f32_32x32x16_bf16 v[160:175], a[228:231], v[80:83], 0
  s_add_u32 s85, s85, 7168
  buffer_load_dwordx4 v[104:107], v1, s[16:19], s85 offen offset:0 sc1
  v_mfma_f32_32x32x16_bf16 v[144:159], a[224:227], v[80:83], 0
  buffer_load_dwordx4 v[108:111], v1, s[16:19], s85 offen offset:1024 sc1
  s_waitcnt vmcnt(6)
  v_mfma_f32_32x32x16_bf16 v[160:175], a[236:239], v[84:87], v[160:175]
  buffer_load_dwordx4 v[112:115], v1, s[16:19], s84 offen offset:0 sc1
  v_mfma_f32_32x32x16_bf16 v[144:159], a[232:235], v[84:87], v[144:159]
  buffer_load_dwordx4 v[116:119], v1, s[16:19], s84 offen offset:1024 sc1
  s_waitcnt vmcnt(7)
  v_mfma_f32_32x32x16_bf16 v[160:175], a[244:247], v[88:91], v[160:175]
  s_add_u32 s84, s84, 7168
  buffer_load_dwordx4 v[120:123], v1, s[16:19], s84 offen offset:0 sc1
  v_mfma_f32_32x32x16_bf16 v[144:159], a[240:243], v[88:91], v[144:159]
  buffer_load_dwordx4 v[124:127], v1, s[16:19], s84 offen offset:1024 sc1
  s_waitcnt vmcnt(8)
  v_mfma_f32_32x32x16_bf16 v[160:175], a[252:255], v[92:95], v[160:175]
  s_add_u32 s84, s84, 7168
  buffer_load_dwordx4 v[128:131], v1, s[16:19], s84 offen offset:0 sc1
  v_mfma_f32_32x32x16_bf16 v[144:159], a[248:251], v[92:95], v[144:159]
  buffer_load_dwordx4 v[132:135], v1, s[16:19], s84 offen offset:1024 sc1
  s_waitcnt vmcnt(9)
  v_mfma_f32_32x32x16_bf16 v[160:175], v[52:55], v[96:99], v[160:175]
  s_add_u32 s84, s84, 7168
  buffer_load_dwordx4 v[136:139], v1, s[16:19], s84 offen offset:0 sc1
  v_mfma_f32_32x32x16_bf16 v[144:159], v[48:51], v[96:99], v[144:159]
  buffer_load_dwordx4 v[140:143], v1, s[16:19], s84 offen offset:1024 sc1
  s_waitcnt vmcnt(10)
  v_mfma_f32_32x32x16_bf16 v[160:175], v[60:63], v[100:103], v[160:175]
  s_add_u32 s87, s87, 7168
  buffer_load_dword v240, v254, s[16:19], s87 offen sc1
  s_add_u32 s87, s87, 7168
  buffer_load_dword v241, v254, s[16:19], s87 offen sc1
  v_mfma_f32_32x32x16_bf16 v[144:159], v[56:59], v[100:103], v[144:159]
  s_add_u32 s87, s87, 7168
  buffer_load_dword v242, v254, s[16:19], s87 offen sc1
  s_add_u32 s87, s87, 7168
  buffer_load_dword v243, v254, s[16:19], s87 offen sc1
  s_waitcnt vmcnt(13)
  v_mfma_f32_32x32x16_bf16 v[160:175], v[68:71], v[104:107], v[160:175]
  s_add_u32 s87, s87, 7168
  buffer_load_dword v244, v254, s[16:19], s87 offen sc1
  s_add_u32 s87, s87, 7168
  buffer_load_dword v245, v254, s[16:19], s87 offen sc1
  v_mfma_f32_32x32x16_bf16 v[144:159], v[64:67], v[104:107], v[144:159]
  s_add_u32 s87, s87, 7168
  buffer_load_dword v246, v254, s[16:19], s87 offen sc1
  s_add_u32 s87, s87, 7168
  buffer_load_dword v247, v254, s[16:19], s87 offen sc1
  s_waitcnt vmcnt(16)
  v_mfma_f32_32x32x16_bf16 v[160:175], v[76:79], v[108:111], v[160:175]
  s_lshr_b32 s68, s36, 1
  s_lshl_b32 s68, s68, 10
  s_lshl_b32 s96, s38, 8
  s_add_u32 s68, s68, s96
  s_mul_i32 s96, s32, 114688
  s_add_u32 s68, s68, s96
  s_lshl_b32 s69, s32, 10
  s_add_u32 m0, s69, 98304
  s_add_u32 s68, s68, 18923520
  buffer_load_dwordx4 v9, s[16:19], s68 offen sc1 lds
  v_mfma_f32_32x32x16_bf16 v[144:159], v[72:75], v[108:111], v[144:159]
  s_mul_i32 s66, s36, 3072
  s_mul_i32 s67, s32, 57344
  s_add_u32 s66, s66, s67
  s_mul_i32 s67, s32, 3072
  s_add_u32 m0, s67, 0
  s_add_u32 s66, s66, 18874368
  buffer_load_dwordx4 v1, s[16:19], s66 offen offset:0 sc1 lds
  s_waitcnt vmcnt(17)
  v_mfma_f32_32x32x16_bf16 v[192:207], a[228:231], v[112:115], 0
  s_add_u32 m0, s67, 0
  s_nop 0
  buffer_load_dwordx4 v1, s[16:19], s66 offen offset:1024 sc1 lds
  v_mfma_f32_32x32x16_bf16 v[176:191], a[224:227], v[112:115], 0
  s_add_u32 m0, s67, 0
  s_nop 0
  buffer_load_dwordx4 v1, s[16:19], s66 offen offset:2048 sc1 lds
  s_waitcnt vmcnt(18)
  v_mfma_f32_32x32x16_bf16 v[192:207], a[236:239], v[116:119], v[192:207]
  s_add_u32 m0, s67, 12288
  s_add_u32 s66, s66, 229376
  buffer_load_dwordx4 v1, s[16:19], s66 offen offset:0 sc1 lds
  ds_write_b128 v19, v[144:147] offset:0
  v_mfma_f32_32x32x16_bf16 v[176:191], a[232:235], v[116:119], v[176:191]
  s_add_u32 m0, s67, 12288
  s_nop 0
  buffer_load_dwordx4 v1, s[16:19], s66 offen offset:1024 sc1 lds
  ds_write_b128 v19, v[148:151] offset:1024
  s_waitcnt vmcnt(19)
  v_mfma_f32_32x32x16_bf16 v[192:207], a[244:247], v[120:123], v[192:207]
  s_add_u32 m0, s67, 12288
  s_nop 0
  buffer_load_dwordx4 v1, s[16:19], s66 offen offset:2048 sc1 lds
  ds_write_b128 v19, v[152:155] offset:2048
  v_mfma_f32_32x32x16_bf16 v[176:191], a[240:243], v[120:123], v[176:191]
  s_add_u32 m0, s69, 102400
  s_add_u32 s68, s68, 458752
  buffer_load_dwordx4 v9, s[16:19], s68 offen sc1 lds
  ds_write_b128 v19, v[156:159] offset:3072
  s_waitcnt vmcnt(20)
  v_mfma_f32_32x32x16_bf16 v[192:207], a[252:255], v[124:127], v[192:207]
  s_add_u32 m0, s67, 24576
  s_add_u32 s66, s66, 229376
  buffer_load_dwordx4 v1, s[16:19], s66 offen offset:0 sc1 lds
  ds_write_b128 v2, v[160:163] offset:4096
  v_mfma_f32_32x32x16_bf16 v[176:191], a[248:251], v[124:127], v[176:191]
  s_add_u32 m0, s67, 24576
  s_nop 0
  buffer_load_dwordx4 v1, s[16:19], s66 offen offset:1024 sc1 lds
  ds_write_b128 v2, v[164:167] offset:5120
  s_waitcnt vmcnt(21)
  v_mfma_f32_32x32x16_bf16 v[192:207], v[52:55], v[128:131], v[192:207]
  s_add_u32 m0, s67, 24576
  s_nop 0
  buffer_load_dwordx4 v1, s[16:19], s66 offen offset:2048 sc1 lds
  ds_write_b128 v2, v[168:171] offset:6144
  s_waitcnt vmcnt(21)
  v_mfma_f32_32x32x16_bf16 v[192:207], v[60:63], v[132:135], v[192:207]
  s_add_u32 m0, s67, 36864
  s_add_u32 s66, s66, 229376
  buffer_load_dwordx4 v1, s[16:19], s66 offen offset:0 sc1 lds
  ds_write_b128 v2, v[172:175] offset:7168
  s_waitcnt vmcnt(21)
  v_mfma_f32_32x32x16_bf16 v[192:207], v[68:71], v[136:139], v[192:207]
  s_add_u32 m0, s67, 36864
  s_nop 0
  buffer_load_dwordx4 v1, s[16:19], s66 offen offset:1024 sc1 lds
  s_waitcnt lgkmcnt(0)
  s_barrier
  ds_read_b128 v[144:147], v18 offset:0
  ds_read_b128 v[148:151], v18 offset:1024
  s_waitcnt vmcnt(21)
  v_mfma_f32_32x32x16_bf16 v[192:207], v[76:79], v[140:143], v[192:207]
  s_add_u32 m0, s67, 36864
  s_nop 0
  buffer_load_dwordx4 v1, s[16:19], s66 offen offset:2048 sc1 lds
  ds_read_b128 v[152:155], v18 offset:2048
  ds_read_b128 v[156:159], v18 offset:3072
  ds_read_b128 v[160:163], v18 offset:4096
  ds_read_b128 v[164:167], v18 offset:5120
  v_mfma_f32_32x32x16_bf16 v[176:191], v[48:51], v[128:131], v[176:191]
  ds_read_b128 v[168:171], v18 offset:6144
  ds_read_b128 v[172:175], v18 offset:7168
  s_waitcnt lgkmcnt(4)
  v_mfma_f32_32x32x16_bf16 v[176:191], v[56:59], v[132:135], v[176:191]
  ds_write_b128 v18, v[192:195] offset:0
  ds_write_b128 v18, v[196:199] offset:1024
  ds_write_b128 v18, v[200:203] offset:2048
  ds_write_b128 v18, v[204:207] offset:3072
  v_mfma_f32_32x32x16_bf16 v[176:191], v[64:67], v[136:139], v[176:191]
  v_mfma_f32_32x32x16_bf16 v[176:191], v[72:75], v[140:143], v[176:191]
  s_waitcnt lgkmcnt(4)
  v_pk_add_f32 v[32:33], v[32:33], v[144:145]
  v_pk_add_f32 v[34:35], v[34:35], v[146:147]
  v_pk_add_f32 v[36:37], v[36:37], v[148:149]
  v_pk_add_f32 v[38:39], v[38:39], v[150:151]
  v_pk_add_f32 v[40:41], v[40:41], v[152:153]
  v_pk_add_f32 v[42:43], v[42:43], v[154:155]
  v_pk_add_f32 v[44:45], v[44:45], v[156:157]
  v_pk_add_f32 v[46:47], v[46:47], v[158:159]
  s_waitcnt lgkmcnt(0)
  s_barrier
  ds_read_b128 v[208:211], v20 offset:0
  ds_read_b128 v[212:215], v20 offset:1024
  ds_read_b128 v[216:219], v20 offset:2048
  ds_read_b128 v[220:223], v20 offset:3072
  v_pk_add_f32 v[32:33], v[32:33], v[160:161]
  v_pk_add_f32 v[34:35], v[34:35], v[162:163]
  v_pk_add_f32 v[36:37], v[36:37], v[164:165]
  v_pk_add_f32 v[38:39], v[38:39], v[166:167]
  v_pk_add_f32 v[40:41], v[40:41], v[168:169]
  v_pk_add_f32 v[42:43], v[42:43], v[170:171]
  v_pk_add_f32 v[44:45], v[44:45], v[172:173]
  v_pk_add_f32 v[46:47], v[46:47], v[174:175]
  v_pk_add_f32 v[32:33], v[32:33], v[176:177]
  v_pk_add_f32 v[34:35], v[34:35], v[178:179]
  v_pk_add_f32 v[36:37], v[36:37], v[180:181]
  v_pk_add_f32 v[38:39], v[38:39], v[182:183]
  v_pk_add_f32 v[40:41], v[40:41], v[184:185]
  v_pk_add_f32 v[42:43], v[42:43], v[186:187]
  v_pk_add_f32 v[44:45], v[44:45], v[188:189]
  v_pk_add_f32 v[46:47], v[46:47], v[190:191]
  s_waitcnt lgkmcnt(3)
  v_pk_add_f32 v[32:33], v[32:33], v[208:209]
  v_pk_add_f32 v[34:35], v[34:35], v[210:211]
  v_cvt_pk_bf16_f32 v80, v32, v33
  v_cvt_pk_bf16_f32 v81, v34, v35
  s_waitcnt lgkmcnt(2)
  v_pk_add_f32 v[36:37], v[36:37], v[212:213]
  v_pk_add_f32 v[38:39], v[38:39], v[214:215]
  v_cvt_pk_bf16_f32 v82, v36, v37
  v_cvt_pk_bf16_f32 v83, v38, v39
  s_waitcnt lgkmcnt(1)
  v_pk_add_f32 v[40:41], v[40:41], v[216:217]
  v_pk_add_f32 v[42:43], v[42:43], v[218:219]
  v_cvt_pk_bf16_f32 v84, v40, v41
  v_cvt_pk_bf16_f32 v85, v42, v43
  s_waitcnt lgkmcnt(0)
  v_pk_add_f32 v[44:45], v[44:45], v[220:221]
  v_pk_add_f32 v[46:47], v[46:47], v[222:223]
  v_cvt_pk_bf16_f32 v86, v44, v45
  v_cvt_pk_bf16_f32 v87, v46, v47
  buffer_store_dwordx4 v[80:83], v1, s[12:15], s80 offen sc1
  buffer_store_dwordx4 v[84:87], v1, s[12:15], s80 offen offset:1024 sc1
  v_dot2_f32_bf16 v248, v80, v252, 0
  v_dot2_f32_bf16 v250, v80, v80, 0
  v_dot2_f32_bf16 v248, v81, v252, v248
  v_dot2_f32_bf16 v250, v81, v81, v250
  v_dot2_f32_bf16 v248, v82, v252, v248
  v_dot2_f32_bf16 v250, v82, v82, v250
  v_dot2_f32_bf16 v248, v83, v252, v248
  v_dot2_f32_bf16 v250, v83, v83, v250
  v_dot2_f32_bf16 v248, v84, v252, v248
  v_dot2_f32_bf16 v250, v84, v84, v250
  v_dot2_f32_bf16 v248, v85, v252, v248
  v_dot2_f32_bf16 v250, v85, v85, v250
  v_dot2_f32_bf16 v248, v86, v252, v248
  v_dot2_f32_bf16 v250, v86, v86, v250
  v_dot2_f32_bf16 v248, v87, v252, v248
  v_dot2_f32_bf16 v250, v87, v87, v250
  s_nop 2
  v_permlane32_swap_b32 v248, v250
  v_add_f32_e64 v248, v248, v250
  buffer_store_dword v248, v12, s[16:19], s81 offen
  s_waitcnt vmcnt(17)
  v_pk_add_f32 v[240:241], v[240:241], v[244:245]
  v_pk_add_f32 v[242:243], v[242:243], v[246:247]
  v_pk_add_f32 v[240:241], v[240:241], v[242:243]
  v_add_f32 v253, v240, v241
  s_add_u32 s87, s87, 7168
  buffer_load_dword v240, v254, s[16:19], s87 offen sc1
  s_add_u32 s87, s87, 7168
  buffer_load_dword v241, v254, s[16:19], s87 offen sc1
  s_add_u32 s87, s87, 7168
  buffer_load_dword v242, v254, s[16:19], s87 offen sc1
  s_add_u32 s87, s87, 7168
  buffer_load_dword v243, v254, s[16:19], s87 offen sc1
  s_add_u32 s87, s87, 7168
  buffer_load_dword v244, v254, s[16:19], s87 offen sc1
  s_add_u32 s87, s87, 7168
  buffer_load_dword v245, v254, s[16:19], s87 offen sc1
  s_add_u32 s87, s87, 7168
  buffer_load_dword v246, v254, s[16:19], s87 offen sc1
  s_add_u32 s87, s87, 7168
  buffer_load_dword v247, v254, s[16:19], s87 offen sc1
  v_mov_b32_e64 v30, 2
  s_mov_b64 exec, 1
  s_cmp_lg_u32 s40, 0
  s_waitcnt vmcnt(8)
  s_cbranch_scc1 L26
  buffer_store_dword v30, off, s[16:19], s42
  s_branch L27
L26:
  buffer_wbl2 sc1
  s_waitcnt vmcnt(0)
  buffer_store_dword v30, off, s[16:19], s42 sc1
L27:
  s_mov_b64 exec, -1
  s_waitcnt vmcnt(1)
  v_pk_add_f32 v[240:241], v[240:241], v[244:245]
  v_pk_add_f32 v[242:243], v[242:243], v[246:247]
  v_pk_add_f32 v[240:241], v[240:241], v[242:243]
  v_add_f32 v240, v240, v241
  v_add_f32 v240, v240, v253
  v_mov_b32 v241, v240
  s_nop 1
  v_permlane32_swap_b32 v240, v241
  v_add_f32 v240, v240, v241
  v_mov_b32_e64 v241, v240
  v_cndmask_b32 v246, v240, v241, s[58:59]
  v_cvt_pk_bf16_f32 v245, v246, 0
  v_lshlrev_b32 v247, 16, v245
  v_sub_f32 v247, v246, v247
  v_cvt_pk_bf16_f32 v244, v246, v247
  v_and_b32 v245, 0xffff0000, v244
  v_sub_f32_e64 v247, v247, v245
  v_cvt_pk_bf16_f32 v245, v246, v247
  s_lshl_b32 s96, s32, 8
  v_add_u32 v246, s96, v16
  ds_write_b64 v246, v[244:245] offset:1024
  v_and_b32 v17, 0x78, v27
  v_add_u32 v17, 147456, v17
  s_waitcnt lgkmcnt(0)
  s_barrier
  buffer_load_dword v30, v3, s[16:19], s41 offen sc1
  ds_read_b128 v[144:147], v1 offset:0
  ds_read_b128 v[148:151], v1 offset:1024
  ds_read_b128 v[152:155], v1 offset:2048
  ds_read_b128 v[156:159], v1 offset:3072
  ds_read_b128 v[160:163], v1 offset:4096
  s_lshl_b32 s72, s63, 15
  s_add_u32 s72, s72, 0
  s_lshl_b32 s73, s63, 12
  s_add_u32 s73, s73, 1572864
  s_mul_i32 s74, s63, 112
  s_mul_i32 s75, s36, 7
  s_add_u32 s74, s74, s75
  s_lshl_b32 s74, s74, 10
  s_add_u32 s74, s74, 8388608
  s_add_u32 s75, s74, 4096
  s_mov_b32 s44, 0
L28:
  buffer_load_dword v7, v3, s[16:19], s41 offen sc1
  s_waitcnt vmcnt(1)
  v_cmp_gt_i32 vcc, 2, v30
  s_cbranch_vccz L29
  buffer_load_dword v30, v3, s[16:19], s41 offen sc1
  s_add_u32 s44, s44, 1
  s_cmp_gt_u32 s44, 200000
  s_cbranch_scc1 Lend
  s_waitcnt vmcnt(1)
  v_cmp_gt_i32_e64 vcc, 2, v7
  s_cbranch_vccnz L28
L29:
  s_cmp_eq_u32 s40, 0
  s_cbranch_scc1 L30
  buffer_inv sc1
  s_waitcnt vmcnt(0)
L30:
  s_nop 0
  buffer_load_dwordx4 v[172:175], v1, s[12:15], s72 offen offset:0 sc1
  buffer_load_dwordx4 v[176:179], v1, s[12:15], s72 offen offset:1024 sc1
  buffer_load_dwordx4 v[180:183], v1, s[12:15], s72 offen offset:2048 sc1
  buffer_load_dwordx4 v[184:187], v1, s[12:15], s72 offen offset:3072 sc1
  s_add_u32 s72, s72, 4096
  buffer_load_dwordx4 v[188:191], v1, s[12:15], s72 offen offset:0 sc1
  s_waitcnt vmcnt(4) lgkmcnt(4)
  v_mfma_f32_32x32x16_bf16 v[80:95], v[144:147], v[172:175], 0
  ds_read_b128 v[164:167], v1 offset:5120
  buffer_load_dwordx4 v[192:195], v1, s[12:15], s72 offen offset:1024 sc1
  s_waitcnt lgkmcnt(4)
  v_mfma_f32_32x32x16_bf16 v[96:111], v[148:151], v[172:175], 0
  ds_read_b128 v[168:171], v1 offset:6144
  s_waitcnt lgkmcnt(4)
  v_mfma_f32_32x32x16_bf16 v[112:127], v[152:155], v[172:175], 0
  ds_read_b128 v[144:147], v1 offset:7168
  buffer_load_dwordx4 v[224:227], v13, s[16:19], s73 offen offset:0 sc1
  s_waitcnt vmcnt(5) lgkmcnt(4)
  v_mfma_f32_32x32x16_bf16 v[80:95], v[156:159], v[176:179], v[80:95]
  ds_read_b128 v[148:151], v1 offset:8192
  s_waitcnt lgkmcnt(4)
  v_mfma_f32_32x32x16_bf16 v[96:111], v[160:163], v[176:179], v[96:111]
  ds_read_b128 v[152:155], v10 offset:49152
  buffer_load_dwordx4 v[196:199], v1, s[12:15], s72 offen offset:2048 sc1
  s_waitcnt lgkmcnt(4)
  v_mfma_f32_32x32x16_bf16 v[112:127], v[164:167], v[176:179], v[112:127]
  ds_read_b128 v[156:159], v1 offset:9216
  s_waitcnt vmcnt(5) lgkmcnt(4)
  v_mfma_f32_32x32x16_bf16 v[80:95], v[168:171], v[180:183], v[80:95]
  ds_read_b128 v[160:163], v1 offset:10240
  buffer_load_dwordx4 v[200:203], v1, s[12:15], s72 offen offset:3072 sc1
  v_permlane16_swap_b32 v172, v176
  v_permlane16_swap_b32 v173, v177
  s_waitcnt lgkmcnt(4)
  v_mfma_f32_32x32x16_bf16 v[96:111], v[144:147], v[180:183], v[96:111]
  ds_read_b128 v[164:167], v1 offset:11264
  v_permlane16_swap_b32 v174, v178
  v_permlane16_swap_b32_e64 v175, v179
  s_waitcnt lgkmcnt(4)
  v_mfma_f32_32x32x16_bf16 v[112:127], v[148:151], v[180:183], v[112:127]
  ds_read_b128 v[168:171], v1 offset:12288
  buffer_load_dwordx4 v[228:231], v13, s[16:19], s73 offen offset:512 sc1
  s_waitcnt lgkmcnt(4)
  v_mfma_f32_16x16x32_bf16 v[128:131], v[152:155], v[172:175], 0
  v_mfma_f32_16x16x32_bf16 v[132:135], v[152:155], v[176:179], 0
  ds_read_b128 v[144:147], v1 offset:13312
  s_waitcnt vmcnt(6) lgkmcnt(4)
  v_mfma_f32_32x32x16_bf16 v[80:95], v[156:159], v[184:187], v[80:95]
  ds_read_b128 v[148:151], v1 offset:14336
  s_waitcnt lgkmcnt(4)
  v_mfma_f32_32x32x16_bf16 v[96:111], v[160:163], v[184:187], v[96:111]
  ds_read_b128 v[152:155], v10 offset:50176
  s_add_u32 s72, s72, 4096
  buffer_load_dwordx4 v[204:207], v1, s[12:15], s72 offen offset:0 sc1
  s_waitcnt lgkmcnt(4)
  v_mfma_f32_32x32x16_bf16 v[112:127], v[164:167], v[184:187], v[112:127]
  ds_read_b128 v[156:159], v1 offset:15360
  s_waitcnt vmcnt(6) lgkmcnt(4)
  v_mfma_f32_32x32x16_bf16 v[80:95], v[168:171], v[188:191], v[80:95]
  ds_read_b128 v[160:163], v1 offset:16384
  buffer_load_dwordx4 v[208:211], v1, s[12:15], s72 offen offset:1024 sc1
  v_permlane16_swap_b32 v180, v184
  v_permlane16_swap_b32 v181, v185
  s_waitcnt lgkmcnt(4)
  v_mfma_f32_32x32x16_bf16 v[96:111], v[144:147], v[188:191], v[96:111]
  ds_read_b128 v[164:167], v1 offset:17408
  v_permlane16_swap_b32 v182, v186
  v_permlane16_swap_b32_e64 v183, v187
  s_waitcnt lgkmcnt(4)
  v_mfma_f32_32x32x16_bf16 v[112:127], v[148:151], v[188:191], v[112:127]
  ds_read_b128 v[168:171], v1 offset:18432
  buffer_load_dwordx4 v[232:235], v13, s[16:19], s73 offen offset:1024 sc1
  s_waitcnt lgkmcnt(4)
  v_mfma_f32_16x16x32_bf16 v[128:131], v[152:155], v[180:183], v[128:131]
  v_mfma_f32_16x16x32_bf16 v[132:135], v[152:155], v[184:187], v[132:135]
  ds_read_b128 v[144:147], v1 offset:19456
  s_waitcnt vmcnt(7) lgkmcnt(4)
  v_mfma_f32_32x32x16_bf16 v[80:95], v[156:159], v[192:195], v[80:95]
  ds_read_b128 v[148:151], v1 offset:20480
  buffer_load_dwordx4 v[212:215], v1, s[12:15], s72 offen offset:2048 sc1
  s_waitcnt lgkmcnt(4)
  v_mfma_f32_32x32x16_bf16 v[96:111], v[160:163], v[192:195], v[96:111]
  ds_read_b128 v[152:155], v10 offset:51200
  s_waitcnt lgkmcnt(4)
  v_mfma_f32_32x32x16_bf16 v[112:127], v[164:167], v[192:195], v[112:127]
  ds_read_b128 v[156:159], v1 offset:21504
  s_waitcnt vmcnt(6) lgkmcnt(4)
  v_mfma_f32_32x32x16_bf16 v[80:95], v[168:171], v[196:199], v[80:95]
  ds_read_b128 v[160:163], v1 offset:22528
  s_add_u32 m0, s69, 106496
  s_add_u32 s68, s68, 458752
  buffer_load_dwordx4 v9, s[16:19], s68 offen sc1 lds
  v_permlane16_swap_b32 v188, v192
  v_permlane16_swap_b32 v189, v193
  s_waitcnt lgkmcnt(4)
  v_mfma_f32_32x32x16_bf16 v[96:111], v[144:147], v[196:199], v[96:111]
  ds_read_b128 v[164:167], v1 offset:23552
  buffer_load_dwordx4 v[216:219], v1, s[12:15], s72 offen offset:3072 sc1
  v_permlane16_swap_b32 v190, v194
  v_permlane16_swap_b32_e64 v191, v195
  s_waitcnt lgkmcnt(4)
  v_mfma_f32_32x32x16_bf16 v[112:127], v[148:151], v[196:199], v[112:127]
  ds_read_b128 v[168:171], v1 offset:24576
  s_add_u32 m0, s67, 49152
  s_add_u32 s66, s66, 229376
  buffer_load_dwordx4 v1, s[16:19], s66 offen offset:0 sc1 lds
  s_waitcnt lgkmcnt(4)
  v_mfma_f32_16x16x32_bf16 v[128:131], v[152:155], v[188:191], v[128:131]
  v_mfma_f32_16x16x32_bf16 v[132:135], v[152:155], v[192:195], v[132:135]
  ds_read_b128 v[144:147], v1 offset:25600
  s_waitcnt vmcnt(8) lgkmcnt(4)
  v_mfma_f32_32x32x16_bf16 v[80:95], v[156:159], v[200:203], v[80:95]
  ds_read_b128 v[148:151], v1 offset:26624
  s_add_u32 s72, s72, 4096
  buffer_load_dwordx4 v[220:223], v1, s[12:15], s72 offen offset:0 sc1
  s_waitcnt lgkmcnt(4)
  v_mfma_f32_32x32x16_bf16 v[96:111], v[160:163], v[200:203], v[96:111]
  ds_read_b128 v[152:155], v10 offset:52224
  s_add_u32 m0, s67, 49152
  s_nop 0
  buffer_load_dwordx4 v1, s[16:19], s66 offen offset:1024 sc1 lds
  s_waitcnt lgkmcnt(4)
  v_mfma_f32_32x32x16_bf16 v[112:127], v[164:167], v[200:203], v[112:127]
  ds_read_b128 v[156:159], v1 offset:27648
  buffer_load_dwordx4 v[172:175], v1, s[12:15], s72 offen offset:1024 sc1
  s_waitcnt vmcnt(9) lgkmcnt(4)
  v_mfma_f32_32x32x16_bf16 v[80:95], v[168:171], v[204:207], v[80:95]
  ds_read_b128 v[160:163], v1 offset:28672
  s_add_u32 m0, s67, 49152
  s_nop 0
  buffer_load_dwordx4 v1, s[16:19], s66 offen offset:2048 sc1 lds
  v_permlane16_swap_b32 v196, v200
  v_permlane16_swap_b32 v197, v201
  s_waitcnt lgkmcnt(4)
  v_mfma_f32_32x32x16_bf16 v[96:111], v[144:147], v[204:207], v[96:111]
  ds_read_b128 v[164:167], v1 offset:29696
  buffer_load_dwordx4 v[176:179], v1, s[12:15], s72 offen offset:2048 sc1
  v_permlane16_swap_b32 v198, v202
  v_permlane16_swap_b32_e64 v199, v203
  s_waitcnt lgkmcnt(4)
  v_mfma_f32_32x32x16_bf16 v[112:127], v[148:151], v[204:207], v[112:127]
  ds_read_b128 v[168:171], v1 offset:30720
  s_waitcnt lgkmcnt(4)
  v_mfma_f32_16x16x32_bf16 v[128:131], v[152:155], v[196:199], v[128:131]
  v_mfma_f32_16x16x32_bf16 v[132:135], v[152:155], v[200:203], v[132:135]
  ds_read_b128 v[144:147], v1 offset:31744
  s_waitcnt vmcnt(10) lgkmcnt(4)
  v_mfma_f32_32x32x16_bf16 v[80:95], v[156:159], v[208:211], v[80:95]
  ds_read_b128 v[148:151], v1 offset:32768
  buffer_load_dwordx4 v[236:239], v13, s[16:19], s73 offen offset:1536 sc1
  s_waitcnt lgkmcnt(4)
  v_mfma_f32_32x32x16_bf16 v[96:111], v[160:163], v[208:211], v[96:111]
  ds_read_b128 v[152:155], v10 offset:53248
  s_waitcnt lgkmcnt(4)
  v_mfma_f32_32x32x16_bf16 v[112:127], v[164:167], v[208:211], v[112:127]
  ds_read_b128 v[156:159], v1 offset:33792
  buffer_load_dwordx4 v[180:183], v1, s[12:15], s72 offen offset:3072 sc1
  s_waitcnt vmcnt(10) lgkmcnt(4)
  v_mfma_f32_32x32x16_bf16 v[80:95], v[168:171], v[212:215], v[80:95]
  ds_read_b128 v[160:163], v1 offset:34816
  v_permlane16_swap_b32 v204, v208
  v_permlane16_swap_b32 v205, v209
  s_waitcnt lgkmcnt(4)
  v_mfma_f32_32x32x16_bf16 v[96:111], v[144:147], v[212:215], v[96:111]
  ds_read_b128 v[164:167], v1 offset:35840
  s_add_u32 m0, s67, 61440
  s_add_u32 s66, s66, 229376
  buffer_load_dwordx4 v1, s[16:19], s66 offen offset:0 sc1 lds
  v_permlane16_swap_b32 v206, v210
  v_permlane16_swap_b32_e64 v207, v211
  s_waitcnt lgkmcnt(4)
  v_mfma_f32_32x32x16_bf16 v[112:127], v[148:151], v[212:215], v[112:127]
  ds_read_b128 v[168:171], v1 offset:36864
  s_add_u32 s72, s72, 4096
  buffer_load_dwordx4 v[184:187], v1, s[12:15], s72 offen offset:0 sc1
  s_waitcnt lgkmcnt(4)
  v_mfma_f32_16x16x32_bf16 v[128:131], v[152:155], v[204:207], v[128:131]
  v_mfma_f32_16x16x32_bf16 v[132:135], v[152:155], v[208:211], v[132:135]
  ds_read_b128 v[144:147], v1 offset:37888
  s_waitcnt vmcnt(10) lgkmcnt(4)
  v_mfma_f32_32x32x16_bf16 v[80:95], v[156:159], v[216:219], v[80:95]
  ds_read_b128 v[148:151], v1 offset:38912
  s_add_u32 m0, s67, 61440
  s_nop 0
  buffer_load_dwordx4 v1, s[16:19], s66 offen offset:1024 sc1 lds
  s_waitcnt lgkmcnt(4)
  v_mfma_f32_32x32x16_bf16 v[96:111], v[160:163], v[216:219], v[96:111]
  ds_read_b128 v[152:155], v10 offset:54272
  buffer_load_dwordx4 v[188:191], v1, s[12:15], s72 offen offset:1024 sc1
  s_waitcnt lgkmcnt(4)
  v_mfma_f32_32x32x16_bf16 v[112:127], v[164:167], v[216:219], v[112:127]
  ds_read_b128 v[156:159], v1 offset:39936
  s_add_u32 m0, s67, 61440
  s_nop 0
  buffer_load_dwordx4 v1, s[16:19], s66 offen offset:2048 sc1 lds
  s_waitcnt vmcnt(11) lgkmcnt(4)
  v_mfma_f32_32x32x16_bf16 v[80:95], v[168:171], v[220:223], v[80:95]
  ds_read_b128 v[160:163], v1 offset:40960
  buffer_load_dwordx4 v[192:195], v1, s[12:15], s72 offen offset:2048 sc1
  v_permlane16_swap_b32 v212, v216
  v_permlane16_swap_b32 v213, v217
  s_waitcnt lgkmcnt(4)
  v_mfma_f32_32x32x16_bf16 v[96:111], v[144:147], v[220:223], v[96:111]
  ds_read_b128 v[164:167], v1 offset:41984
  v_permlane16_swap_b32 v214, v218
  v_permlane16_swap_b32_e64 v215, v219
  s_waitcnt lgkmcnt(4)
  v_mfma_f32_32x32x16_bf16 v[112:127], v[148:151], v[220:223], v[112:127]
  ds_read_b128 v[168:171], v1 offset:43008
  buffer_load_dwordx4 v[196:199], v1, s[12:15], s72 offen offset:3072 sc1
  s_waitcnt lgkmcnt(4)
  v_mfma_f32_16x16x32_bf16 v[128:131], v[152:155], v[212:215], v[128:131]
  v_mfma_f32_16x16x32_bf16 v[132:135], v[152:155], v[216:219], v[132:135]
  ds_read_b128 v[144:147], v1 offset:44032
  s_waitcnt vmcnt(11) lgkmcnt(4)
  v_mfma_f32_32x32x16_bf16 v[80:95], v[156:159], v[172:175], v[80:95]
  ds_read_b128 v[148:151], v1 offset:45056
  s_add_u32 s72, s72, 4096
  buffer_load_dwordx4 v[200:203], v1, s[12:15], s72 offen offset:0 sc1
  s_waitcnt lgkmcnt(4)
  v_mfma_f32_32x32x16_bf16 v[96:111], v[160:163], v[172:175], v[96:111]
  ds_read_b128 v[152:155], v10 offset:55296
  s_waitcnt lgkmcnt(4)
  v_mfma_f32_32x32x16_bf16 v[112:127], v[164:167], v[172:175], v[112:127]
  ds_read_b128 v[156:159], v1 offset:46080
  buffer_load_dwordx4 v[204:207], v1, s[12:15], s72 offen offset:1024 sc1
  s_waitcnt vmcnt(10)
  s_waitcnt lgkmcnt(4)
  v_mfma_f32_32x32x16_bf16 v[80:95], v[168:171], v[176:179], v[80:95]
  ds_read_b128 v[160:163], v1 offset:47104
  v_add_f32 v224, v224, v232
  v_add_f32 v225, v225, v233
  v_permlane16_swap_b32 v220, v172
  v_permlane16_swap_b32_e64 v221, v173
  s_waitcnt lgkmcnt(4)
  v_mfma_f32_32x32x16_bf16 v[96:111], v[144:147], v[176:179], v[96:111]
  ds_read_b128 v[164:167], v1 offset:48128
  s_add_u32 m0, s69, 110592
  s_add_u32 s68, s68, 458752
  buffer_load_dwordx4 v9, s[16:19], s68 offen sc1 lds
  v_add_f32 v226, v226, v234
  v_add_f32 v227, v227, v235
  v_permlane16_swap_b32 v222, v174
  v_permlane16_swap_b32_e64 v223, v175
  s_waitcnt lgkmcnt(4)
  v_mfma_f32_32x32x16_bf16 v[112:127], v[148:151], v[176:179], v[112:127]
  s_barrier
  ds_read_b128 v[168:171], v10 offset:0
  buffer_load_dwordx4 v[208:211], v1, s[12:15], s72 offen offset:2048 sc1
  v_add_f32 v228, v228, v236
  v_add_f32 v229, v229, v237
  s_waitcnt lgkmcnt(4)
  v_mfma_f32_16x16x32_bf16 v[128:131], v[152:155], v[220:223], v[128:131]
  v_mfma_f32_16x16x32_bf16 v[132:135], v[152:155], v[172:175], v[132:135]
  ds_read_b128 v[144:147], v10 offset:1024
  s_waitcnt vmcnt(11) lgkmcnt(4)
  v_mfma_f32_32x32x16_bf16 v[80:95], v[156:159], v[180:183], v[80:95]
  ds_read_b128 v[148:151], v10 offset:2048
  s_add_u32 m0, s67, 73728
  s_add_u32 s66, s66, 229376
  buffer_load_dwordx4 v1, s[16:19], s66 offen offset:0 sc1 lds
  v_add_f32 v230, v230, v238
  v_add_f32 v231, v231, v239
  s_waitcnt lgkmcnt(4)
  v_mfma_f32_32x32x16_bf16 v[96:111], v[160:163], v[180:183], v[96:111]
  ds_read_b128 v[152:155], v10 offset:56320
  buffer_load_dwordx4 v[212:215], v1, s[12:15], s72 offen offset:3072 sc1
  v_add_f32 v224, v224, v228
  v_add_f32_e64 v225, v225, v229
  s_waitcnt lgkmcnt(4)
  v_mfma_f32_32x32x16_bf16 v[112:127], v[164:167], v[180:183], v[112:127]
  ds_read_b128 v[156:159], v10 offset:3072
  s_add_u32 m0, s67, 73728
  s_nop 0
  buffer_load_dwordx4 v1, s[16:19], s66 offen offset:1024 sc1 lds
  v_add_f32 v226, v226, v230
  v_add_f32 v227, v227, v231
  s_waitcnt vmcnt(12) lgkmcnt(4)
  v_mfma_f32_32x32x16_bf16 v[80:95], v[168:171], v[184:187], v[80:95]
  ds_read_b128 v[160:163], v10 offset:4096
  s_add_u32 s72, s72, 4096
  buffer_load_dwordx4 v[216:219], v1, s[12:15], s72 offen offset:0 sc1
  v_add_f32 v224, v224, v226
  v_add_f32 v225, v225, v227
  v_permlane16_swap_b32 v176, v180
  v_permlane16_swap_b32_e64 v177, v181
  s_waitcnt lgkmcnt(4)
  v_mfma_f32_32x32x16_bf16 v[96:111], v[144:147], v[184:187], v[96:111]
  ds_read_b128 v[164:167], v10 offset:5120
  s_add_u32 m0, s67, 73728
  s_nop 0
  buffer_load_dwordx4 v1, s[16:19], s66 offen offset:2048 sc1 lds
  v_mov_b32 v226, v224
  v_mov_b32 v227, v225
  v_permlane16_swap_b32 v178, v182
  v_permlane16_swap_b32 v179, v183
  s_waitcnt lgkmcnt(4)
  v_mfma_f32_32x32x16_bf16 v[112:127], v[148:151], v[184:187], v[112:127]
  ds_read_b128 v[168:171], v10 offset:6144
  s_add_u32 m0, s67, 86016
  s_add_u32 s66, s66, 229376
  buffer_load_dwordx4 v1, s[16:19], s66 offen offset:0 sc1 lds
  v_permlane32_swap_b32 v224, v226
  v_permlane32_swap_b32_e64 v225, v227
  s_waitcnt lgkmcnt(4)
  v_mfma_f32_16x16x32_bf16 v[128:131], v[152:155], v[176:179], v[128:131]
  v_mfma_f32_16x16x32_bf16 v[132:135], v[152:155], v[180:183], v[132:135]
  ds_read_b128 v[144:147], v10 offset:7168
  s_waitcnt vmcnt(13) lgkmcnt(4)
  v_mfma_f32_32x32x16_bf16 v[80:95], v[156:159], v[188:191], v[80:95]
  ds_read_b128 v[148:151], v10 offset:8192
  buffer_load_dwordx4 v[220:223], v1, s[12:15], s72 offen offset:1024 sc1
  v_add_f32 v224, v224, v226
  v_add_f32 v225, v225, v227
  s_waitcnt lgkmcnt(4)
  v_mfma_f32_32x32x16_bf16 v[96:111], v[160:163], v[188:191], v[96:111]
  ds_read_b128 v[152:155], v10 offset:57344
  v_mul_f32 v248, 0x3b000000, v224
  v_mul_f32 v250, 0x3b000000, v225
  s_waitcnt lgkmcnt(4)
  v_mfma_f32_32x32x16_bf16 v[112:127], v[164:167], v[188:191], v[112:127]
  ds_read_b128 v[156:159], v10 offset:9216
  s_add_u32 m0, s67, 86016
  s_nop 0
  buffer_load_dwordx4 v1, s[16:19], s66 offen offset:1024 sc1 lds
  v_fma_f32 v250, -v248, v248, v250
  v_max_f32 v250, 0, v250
  s_waitcnt vmcnt(13) lgkmcnt(4)
  v_mfma_f32_32x32x16_bf16 v[80:95], v[168:171], v[192:195], v[80:95]
  ds_read_b128 v[160:163], v10 offset:10240
  v_add_f32 v250, 0x3727c5ac, v250
  v_rsq_f32 v250, v250
  v_permlane16_swap_b32 v184, v188
  v_permlane16_swap_b32 v185, v189
  s_waitcnt lgkmcnt(4)
  v_mfma_f32_32x32x16_bf16 v[96:111], v[144:147], v[192:195], v[96:111]
  ds_read_b128 v[164:167], v10 offset:11264
  v_cvt_pk_bf16_f32 v228, -v248, -v248
  v_and_b32 v229, 0xffff0000, v228
  v_permlane16_swap_b32 v186, v190
  v_permlane16_swap_b32_e64 v187, v191
  s_waitcnt lgkmcnt(4)
  v_mfma_f32_32x32x16_bf16 v[112:127], v[148:151], v[192:195], v[112:127]
  s_barrier
  ds_read_b128 v[168:171], v10 offset:12288
  s_add_u32 m0, s67, 86016
  s_nop 0
  buffer_load_dwordx4 v1, s[16:19], s66 offen offset:2048 sc1 lds
  v_add_f32_e64 v229, v248, v229
  v_cvt_pk_bf16_f32 v229, -v229, -v248
  s_waitcnt lgkmcnt(4)
  v_mfma_f32_16x16x32_bf16 v[128:131], v[152:155], v[184:187], v[128:131]
  v_mfma_f32_16x16x32_bf16 v[132:135], v[152:155], v[188:191], v[132:135]
  ds_read_b128 v[144:147], v10 offset:13312
  s_waitcnt vmcnt(13) lgkmcnt(4)
  v_mfma_f32_32x32x16_bf16 v[80:95], v[156:159], v[196:199], v[80:95]
  ds_read_b128 v[148:151], v10 offset:14336
  buffer_load_dwordx4 v[172:175], v1, s[12:15], s72 offen offset:2048 sc1
  v_cndmask_b32 v252, 0, v228, s[52:53]
  v_cndmask_b32 v253, 0, v229, s[52:53]
  s_waitcnt lgkmcnt(4)
  v_mfma_f32_32x32x16_bf16 v[96:111], v[160:163], v[196:199], v[96:111]
  ds_read_b128 v[152:155], v10 offset:58368
  v_mov_b32 v254, 0
  v_mov_b32 v255, 0
  s_waitcnt lgkmcnt(4)
  v_mfma_f32_32x32x16_bf16 v[112:127], v[164:167], v[196:199], v[112:127]
  ds_read_b128 v[156:159], v10 offset:15360
  buffer_load_dwordx4 v[176:179], v1, s[12:15], s72 offen offset:3072 sc1
  v_cndmask_b32 v240, 0, v228, s[54:55]
  v_cndmask_b32 v241, 0, v229, s[54:55]
  s_waitcnt vmcnt(14) lgkmcnt(4)
  v_mfma_f32_32x32x16_bf16 v[80:95], v[168:171], v[200:203], v[80:95]
  ds_read_b128 v[160:163], v10 offset:16384
  v_mov_b32 v242, 0
  v_mov_b32 v243, 0
  v_permlane16_swap_b32 v192, v196
  v_permlane16_swap_b32 v193, v197
  s_waitcnt lgkmcnt(4)
  v_mfma_f32_32x32x16_bf16 v[96:111], v[144:147], v[200:203], v[96:111]
  ds_read_b128 v[164:167], v10 offset:17408
  s_add_u32 s72, s72, 4096
  buffer_load_dwordx4 v[180:183], v1, s[12:15], s72 offen offset:0 sc1
  v_cndmask_b32 v244, 0, v228, s[56:57]
  v_cndmask_b32 v245, 0, v229, s[56:57]
  v_permlane16_swap_b32 v194, v198
  v_permlane16_swap_b32_e64 v195, v199
  s_waitcnt lgkmcnt(4)
  v_mfma_f32_32x32x16_bf16 v[112:127], v[148:151], v[200:203], v[112:127]
  ds_read_b128 v[168:171], v10 offset:18432
  v_mov_b32 v246, 0
  v_mov_b32_e64 v247, 0
  s_waitcnt lgkmcnt(4)
  v_mfma_f32_16x16x32_bf16 v[128:131], v[152:155], v[192:195], v[128:131]
  v_mfma_f32_16x16x32_bf16 v[132:135], v[152:155], v[196:199], v[132:135]
  ds_read_b128 v[144:147], v10 offset:19456
  s_waitcnt vmcnt(14) lgkmcnt(4)
  v_mfma_f32_32x32x16_bf16 v[80:95], v[156:159], v[204:207], v[80:95]
  ds_read_b128 v[148:151], v10 offset:20480
  buffer_load_dwordx4 v[184:187], v1, s[12:15], s72 offen offset:1024 sc1
  ds_write_b32 v24, v250 offset:2560
  s_waitcnt lgkmcnt(5)
  v_mfma_f32_32x32x16_bf16 v[96:111], v[160:163], v[204:207], v[96:111]
  ds_read_b128 v[152:155], v10 offset:59392
  s_waitcnt lgkmcnt(5)
  v_mfma_f32_32x32x16_bf16 v[112:127], v[164:167], v[204:207], v[112:127]
  ds_read_b128 v[156:159], v10 offset:21504
  s_lshl_b32 s98, s38, 2
  s_add_u32 s98, s98, s32
  s_mul_i32 s98, s98, 229376
  s_lshl_b32 s96, s39, 11
  s_add_u32 s98, s98, s96
  s_add_u32 s98, s98, 21102592
  buffer_load_dwordx4 a[64:67], v5, s[16:19], s98 offen sc1
  s_waitcnt vmcnt(14) lgkmcnt(5)
  v_mfma_f32_32x32x16_bf16 v[80:95], v[168:171], v[208:211], v[80:95]
  ds_read_b128 v[160:163], v10 offset:22528
  v_permlane16_swap_b32 v200, v204
  v_permlane16_swap_b32_e64 v201, v205
  s_waitcnt lgkmcnt(5)
  v_mfma_f32_32x32x16_bf16 v[96:111], v[144:147], v[208:211], v[96:111]
  ds_read_b128 v[164:167], v10 offset:23552
  buffer_load_dwordx4 v[188:191], v1, s[12:15], s72 offen offset:2048 sc1
  v_permlane16_swap_b32 v202, v206
  v_permlane16_swap_b32_e64 v203, v207
  s_waitcnt lgkmcnt(5)
  v_mfma_f32_32x32x16_bf16 v[112:127], v[148:151], v[208:211], v[112:127]
  s_waitcnt vmcnt(10)
  s_barrier
  ds_read_b128 v[168:171], v10 offset:24576
  s_waitcnt lgkmcnt(4)
  v_mfma_f32_16x16x32_bf16 v[128:131], v[152:155], v[200:203], v[128:131]
  v_mfma_f32_16x16x32_bf16 v[132:135], v[152:155], v[204:207], v[132:135]
  ds_read_b128 v[144:147], v10 offset:25600
  s_waitcnt lgkmcnt(4)
  v_mfma_f32_32x32x16_bf16 v[80:95], v[156:159], v[212:215], v[80:95]
  ds_read_b128 v[148:151], v10 offset:26624
  buffer_load_dwordx4 v[192:195], v1, s[12:15], s72 offen offset:3072 sc1
  s_waitcnt lgkmcnt(4)
  v_mfma_f32_32x32x16_bf16 v[96:111], v[160:163], v[212:215], v[96:111]
  ds_read_b128 v[152:155], v10 offset:60416
  s_waitcnt lgkmcnt(4)
  v_mfma_f32_32x32x16_bf16 v[112:127], v[164:167], v[212:215], v[112:127]
  ds_read_b128 v[156:159], v10 offset:27648
  buffer_load_dwordx4 a[68:71], v6, s[16:19], s98 offen sc1
  s_waitcnt lgkmcnt(4)
  v_mfma_f32_32x32x16_bf16 v[80:95], v[168:171], v[216:219], v[80:95]
  ds_read_b128 v[160:163], v10 offset:28672
  v_permlane16_swap_b32 v208, v212
  v_permlane16_swap_b32 v209, v213
  s_waitcnt lgkmcnt(4)
  v_mfma_f32_32x32x16_bf16 v[96:111], v[144:147], v[216:219], v[96:111]
  ds_read_b128 v[164:167], v10 offset:29696
  s_add_u32 s98, s98, 16384
  buffer_load_dwordx4 a[72:75], v5, s[16:19], s98 offen sc1
  v_permlane16_swap_b32 v210, v214
  v_permlane16_swap_b32_e64 v211, v215
  s_waitcnt lgkmcnt(4)
  v_mfma_f32_32x32x16_bf16 v[112:127], v[148:151], v[216:219], v[112:127]
  ds_read_b64 v[168:169], v16 offset:1024
  s_waitcnt lgkmcnt(4)
  v_mfma_f32_16x16x32_bf16 v[128:131], v[152:155], v[208:211], v[128:131]
  v_mfma_f32_16x16x32_bf16 v[132:135], v[152:155], v[212:215], v[132:135]
  ds_read_b64 v[144:145], v16 offset:1280
  s_waitcnt vmcnt(11) lgkmcnt(4)
  v_mfma_f32_32x32x16_bf16 v[80:95], v[156:159], v[220:223], v[80:95]
  ds_read_b64 v[148:149], v16 offset:1536
  buffer_load_dwordx4 a[76:79], v6, s[16:19], s98 offen sc1
  s_waitcnt lgkmcnt(4)
  v_mfma_f32_32x32x16_bf16 v[96:111], v[160:163], v[220:223], v[96:111]
  ds_read_b64 v[152:153], v17 offset:1792
  s_waitcnt lgkmcnt(4)
  v_mfma_f32_32x32x16_bf16 v[112:127], v[164:167], v[220:223], v[112:127]
  ds_read_b128 v[156:159], v10 offset:30720
  s_add_u32 s98, s98, 16384
  buffer_load_dwordx4 a[80:83], v5, s[16:19], s98 offen sc1
  s_waitcnt lgkmcnt(4)
  v_mfma_f32_32x32x16_bf16 v[80:95], v[168:171], v[252:255], v[80:95]
  ds_read_b128 v[160:163], v10 offset:31744
  s_waitcnt lgkmcnt(4)
  v_mfma_f32_32x32x16_bf16 v[96:111], v[144:147], v[252:255], v[96:111]
  ds_read_b128 v[164:167], v10 offset:32768
  s_waitcnt lgkmcnt(4)
  v_mfma_f32_32x32x16_bf16 v[112:127], v[148:151], v[252:255], v[112:127]
  ds_read_b128 v[168:171], v10 offset:61440
  buffer_load_dwordx4 a[84:87], v6, s[16:19], s98 offen sc1
  s_waitcnt lgkmcnt(4)
  v_mfma_f32_16x16x32_bf16 v[128:131], v[152:155], v[240:243], v[128:131]
  v_mfma_f32_16x16x32_bf16 v[132:135], v[152:155], v[244:247], v[132:135]
  ds_read_b128 v[144:147], v10 offset:33792
  s_waitcnt vmcnt(11) lgkmcnt(4)
  v_mfma_f32_32x32x16_bf16 v[80:95], v[156:159], v[172:175], v[80:95]
  ds_read_b128 v[148:151], v10 offset:34816
  s_add_u32 s98, s98, 16384
  buffer_load_dwordx4 a[88:91], v5, s[16:19], s98 offen sc1
  v_permlane16_swap_b32 v216, v220
  v_permlane16_swap_b32 v217, v221
  s_waitcnt lgkmcnt(4)
  v_mfma_f32_32x32x16_bf16 v[96:111], v[160:163], v[172:175], v[96:111]
  ds_read_b128 v[152:155], v10 offset:35840
  v_permlane16_swap_b32 v218, v222
  v_permlane16_swap_b32_e64 v219, v223
  s_waitcnt lgkmcnt(4)
  v_mfma_f32_32x32x16_bf16 v[112:127], v[164:167], v[172:175], v[112:127]
  s_barrier
  ds_read_b128 v[156:159], v10 offset:36864
  s_waitcnt lgkmcnt(4)
  v_mfma_f32_16x16x32_bf16 v[128:131], v[168:171], v[216:219], v[128:131]
  v_mfma_f32_16x16x32_bf16 v[132:135], v[168:171], v[220:223], v[132:135]
  ds_read_b128 v[160:163], v10 offset:39936
  s_waitcnt vmcnt(11) lgkmcnt(4)
  v_mfma_f32_32x32x16_bf16 v[80:95], v[144:147], v[176:179], v[80:95]
  ds_read_b128 v[164:167], v10 offset:43008
  buffer_load_dwordx4 a[92:95], v6, s[16:19], s98 offen sc1
  s_waitcnt lgkmcnt(4)
  v_mfma_f32_32x32x16_bf16 v[96:111], v[148:151], v[176:179], v[96:111]
  ds_read_b128 v[168:171], v10 offset:62464
  s_waitcnt lgkmcnt(4)
  v_mfma_f32_32x32x16_bf16 v[112:127], v[152:155], v[176:179], v[112:127]
  ds_read_b128 v[144:147], v10 offset:46080
  s_add_u32 s98, s98, 16384
  buffer_load_dwordx4 a[96:99], v5, s[16:19], s98 offen sc1
  s_waitcnt vmcnt(12) lgkmcnt(4)
  v_mfma_f32_32x32x16_bf16 v[80:95], v[156:159], v[180:183], v[80:95]
  ds_read_b128 v[148:151], v10 offset:37888
  v_permlane16_swap_b32 v172, v176
  v_permlane16_swap_b32_e64 v173, v177
  s_waitcnt vmcnt(11) lgkmcnt(4)
  v_mfma_f32_32x32x16_bf16 v[80:95], v[160:163], v[184:187], v[80:95]
  ds_read_b128 v[152:155], v10 offset:40960
  v_permlane16_swap_b32 v174, v178
  v_permlane16_swap_b32_e64 v175, v179
  s_waitcnt vmcnt(9) lgkmcnt(4)
  v_mfma_f32_32x32x16_bf16 v[80:95], v[164:167], v[188:191], v[80:95]
  ds_read_b128 v[156:159], v10 offset:44032
  s_waitcnt lgkmcnt(4)
  v_mfma_f32_16x16x32_bf16 v[128:131], v[168:171], v[172:175], v[128:131]
  v_mfma_f32_16x16x32_bf16 v[132:135], v[168:171], v[176:179], v[132:135]
  ds_read_b128 v[160:163], v10 offset:47104
  s_waitcnt vmcnt(8) lgkmcnt(4)
  v_mfma_f32_32x32x16_bf16 v[80:95], v[144:147], v[192:195], v[80:95]
  ds_read_b128 v[164:167], v10 offset:38912
  s_waitcnt lgkmcnt(4)
  v_mfma_f32_32x32x16_bf16 v[96:111], v[148:151], v[180:183], v[96:111]
  ds_read_b128 v[168:171], v10 offset:41984
  s_waitcnt lgkmcnt(4)
  v_mfma_f32_32x32x16_bf16 v[96:111], v[152:155], v[184:187], v[96:111]
  ds_read_b128 v[144:147], v10 offset:45056
  s_nop 4
  s_nop 0
  v_cvt_pk_bf16_f32 v224, v80, v81
  v_cvt_pk_bf16_f32 v225, v82, v83
  v_cvt_pk_bf16_f32 v226, v84, v85
  v_cvt_pk_bf16_f32 v227, v86, v87
  v_pk_max_i16 v224, v224, 0
  v_pk_max_i16 v225, v225, 0
  s_waitcnt lgkmcnt(4)
  v_mfma_f32_32x32x16_bf16 v[96:111], v[156:159], v[188:191], v[96:111]
  s_nop 0
  ds_read_b128 v[148:151], v10 offset:63488
  v_pk_max_i16 v226, v226, 0
  v_pk_max_i16 v227, v227, 0
  buffer_store_dwordx4 v[224:227], v1, s[16:19], s74 offen offset:0
  v_cvt_pk_bf16_f32 v228, v88, v89
  v_cvt_pk_bf16_f32 v229, v90, v91
  v_cvt_pk_bf16_f32 v230, v92, v93
  s_waitcnt lgkmcnt(4)
  v_mfma_f32_32x32x16_bf16 v[96:111], v[160:163], v[192:195], v[96:111]
  s_nop 0
  ds_read_b128 v[152:155], v10 offset:48128
  v_cvt_pk_bf16_f32 v231, v94, v95
  v_pk_max_i16 v228, v228, 0
  v_pk_max_i16 v229, v229, 0
  v_pk_max_i16 v230, v230, 0
  v_pk_max_i16 v231, v231, 0
  buffer_store_dwordx4 v[228:231], v1, s[16:19], s74 offen offset:1024
  s_waitcnt lgkmcnt(4)
  v_mfma_f32_32x32x16_bf16 v[112:127], v[164:167], v[180:183], v[112:127]
  ds_read_b128 v[156:159], v10 offset:64512
  s_waitcnt lgkmcnt(4)
  v_mfma_f32_32x32x16_bf16 v[112:127], v[168:171], v[184:187], v[112:127]
  v_cvt_pk_bf16_f32 v232, v96, v97
  v_cvt_pk_bf16_f32 v233, v98, v99
  v_cvt_pk_bf16_f32 v234, v100, v101
  v_cvt_pk_bf16_f32 v235, v102, v103
  v_pk_max_i16 v232, v232, 0
  v_pk_max_i16 v233, v233, 0
  v_permlane16_swap_b32 v180, v184
  v_permlane16_swap_b32 v181, v185
  v_permlane16_swap_b32 v182, v186
  v_permlane16_swap_b32_e64 v183, v187
  s_waitcnt lgkmcnt(3)
  v_mfma_f32_32x32x16_bf16 v[112:127], v[144:147], v[188:191], v[112:127]
  v_pk_max_i16 v234, v234, 0
  v_pk_max_i16 v235, v235, 0
  buffer_store_dwordx4 v[232:235], v1, s[16:19], s74 offen offset:2048 sc1
  v_cvt_pk_bf16_f32 v236, v104, v105
  v_cvt_pk_bf16_f32 v237, v106, v107
  v_cvt_pk_bf16_f32 v238, v108, v109
  s_waitcnt lgkmcnt(2)
  v_mfma_f32_16x16x32_bf16 v[128:131], v[148:151], v[180:183], v[128:131]
  v_mfma_f32_16x16x32_bf16 v[132:135], v[148:151], v[184:187], v[132:135]
  s_waitcnt lgkmcnt(1)
  v_mfma_f32_32x32x16_bf16 v[112:127], v[152:155], v[192:195], v[112:127]
  v_cvt_pk_bf16_f32 v239, v110, v111
  v_pk_max_i16 v236, v236, 0
  v_pk_max_i16 v237, v237, 0
  v_pk_max_i16 v238, v238, 0
  v_pk_max_i16 v239, v239, 0
  buffer_store_dwordx4 v[236:239], v1, s[16:19], s74 offen offset:3072 sc1
  v_permlane16_swap_b32 v188, v192
  v_permlane16_swap_b32 v189, v193
  v_permlane16_swap_b32 v190, v194
  v_permlane16_swap_b32 v191, v195
  s_waitcnt lgkmcnt(0)
  s_nop 0
  v_mfma_f32_16x16x32_bf16 v[128:131], v[156:159], v[188:191], v[128:131]
  v_mfma_f32_16x16x32_bf16 v[132:135], v[156:159], v[192:195], v[132:135]
  v_cvt_pk_bf16_f32 v224, v112, v113
  v_cvt_pk_bf16_f32 v225, v114, v115
  v_cvt_pk_bf16_f32 v226, v116, v117
  v_cvt_pk_bf16_f32 v227, v118, v119
  v_pk_max_i16 v224, v224, 0
  v_pk_max_i16 v225, v225, 0
  v_pk_max_i16 v226, v226, 0
  v_pk_max_i16 v227, v227, 0
  buffer_store_dwordx4 v[224:227], v1, s[16:19], s75 offen offset:0 sc1
  v_cvt_pk_bf16_f32 v228, v120, v121
  v_cvt_pk_bf16_f32 v229, v122, v123
  v_cvt_pk_bf16_f32 v230, v124, v125
  v_cvt_pk_bf16_f32 v231, v126, v127
  v_pk_max_i16 v228, v228, 0
  v_pk_max_i16 v229, v229, 0
  v_pk_max_i16 v230, v230, 0
  v_pk_max_i16 v231, v231, 0
  buffer_store_dwordx4 v[228:231], v1, s[16:19], s75 offen offset:1024 sc1
  v_cvt_pk_bf16_f32 v240, v128, v129
  v_cvt_pk_bf16_f32 v241, v130, v131
  v_pk_max_i16 v240, v240, 0
  v_pk_max_i16 v241, v241, 0
  buffer_store_dwordx2 v[240:241], v11, s[16:19], s75 offen offset:2048 sc1
  v_cvt_pk_bf16_f32 v242, v132, v133
  v_cvt_pk_bf16_f32 v243, v134, v135
  v_pk_max_i16 v242, v242, 0
  v_pk_max_i16 v243, v243, 0
  buffer_store_dwordx2 v[242:243], v11, s[16:19], s75 offen offset:2304 sc1
  s_barrier
  s_mul_i32 s96, s32, 3072
  v_add_u32 v244, s96, v1
  v_add_u32_e64 v245, s96, v10
  ds_read_b128 a[208:211], v244 offset:0
  ds_write_b128 v244, a[112:115] offset:0
  ds_read_b128 a[212:215], v244 offset:1024
  ds_write_b128 v244, a[116:119] offset:1024
  ds_read_b128 a[216:219], v244 offset:2048
  ds_write_b128 v244, a[120:123] offset:2048
  ds_read_b128 a[220:223], v244 offset:12288
  ds_write_b128 v244, a[124:127] offset:12288
  ds_read_b128 a[112:115], v244 offset:13312
  ds_write_b128 v244, a[128:131] offset:13312
  ds_read_b128 a[116:119], v244 offset:14336
  ds_write_b128 v244, a[132:135] offset:14336
  ds_read_b128 a[120:123], v244 offset:24576
  ds_write_b128 v244, a[136:139] offset:24576
  ds_read_b128 a[124:127], v244 offset:25600
  ds_write_b128 v244, a[140:143] offset:25600
  ds_read_b128 a[128:131], v244 offset:26624
  ds_write_b128 v244, a[144:147] offset:26624
  ds_read_b128 a[132:135], v244 offset:36864
  ds_write_b128 v244, a[148:151] offset:36864
  ds_read_b128 a[136:139], v244 offset:37888
  ds_write_b128 v244, a[152:155] offset:37888
  ds_read_b128 a[140:143], v244 offset:38912
  ds_write_b128 v244, a[156:159] offset:38912
  ds_read_b128 a[144:147], v245 offset:0
  ds_write_b128 v245, a[160:163] offset:0
  ds_read_b128 a[148:151], v245 offset:1024
  ds_write_b128 v245, a[164:167] offset:1024
  ds_read_b128 a[152:155], v245 offset:2048
  ds_write_b128 v245, a[168:171] offset:2048
  ds_read_b128 a[156:159], v245 offset:12288
  ds_write_b128 v245, a[172:175] offset:12288
  ds_read_b128 a[160:163], v245 offset:13312
  ds_write_b128 v245, a[176:179] offset:13312
  ds_read_b128 a[164:167], v245 offset:14336
  ds_write_b128 v245, a[180:183] offset:14336
  ds_read_b128 a[168:171], v245 offset:24576
  ds_write_b128 v245, a[184:187] offset:24576
  ds_read_b128 a[172:175], v245 offset:25600
  ds_write_b128 v245, a[188:191] offset:25600
  v_mov_b32_e64 v30, 3
  s_mov_b64 exec, 1
  s_cmp_lg_u32 s40, 0
  s_waitcnt vmcnt(0)
  s_cbranch_scc1 L31
  buffer_store_dword v30, off, s[16:19], s42
  s_branch L32
L31:
  buffer_wbl2 sc1
  s_waitcnt vmcnt(0)
  buffer_store_dword v30, off, s[16:19], s42 sc1
L32:
  s_mov_b64 exec, -1
  s_nop 0
  ds_read_b128 a[176:179], v245 offset:26624
  ds_write_b128 v245, a[192:195] offset:26624
  ds_read_b128 a[180:183], v245 offset:36864
  ds_write_b128 v245, a[196:199] offset:36864
  ds_read_b128 a[184:187], v245 offset:37888
  ds_write_b128 v245, a[200:203] offset:37888
  ds_read_b128 a[188:191], v245 offset:38912
  ds_write_b128 v245, a[204:207] offset:38912
  s_lshl_b32 s78, s38, 2
  s_add_u32 s78, s78, s32
  s_mul_i32 s78, s78, 14336
  s_add_u32 s78, s78, 8388608
  s_xor_b32 s72, s46, 3
  s_mul_i32 s72, s72, 114688
  s_add_u32 s72, s72, s78
  s_xor_b32 s73, s46, 2
  s_mul_i32 s73, s73, 114688
  s_add_u32 s73, s73, s78
  s_xor_b32 s74, s46, 1
  s_mul_i32 s74, s74, 114688
  s_add_u32 s74, s74, s78
  s_xor_b32 s75, s46, 0
  s_mul_i32 s75, s75, 114688
  s_add_u32 s75, s75, s78
  s_add_u32 s80, s61, 0
  s_add_u32 s81, s62, 1572864
  s_add_u32 s76, s61, 0
  s_xor_b32 s77, s76, 0x10000
  s_sub_u32 s79, s42, s41
  s_xor_b32 s79, s79, 16
  v_mov_b32 v254, s79
  s_lshl_b32 s79, s35, 8
  v_add_u32_e64 v253, s79, v28
  v_mov_b32 v252, 0x3f803f80
  v_and_b32 v31, 1, v0
  v_lshlrev_b32 v31, 4, v31
  s_mov_b32 s79, 0x3f80
  v_lshlrev_b32 v31, v31, s79
  buffer_load_dword v30, v253, s[16:19], s41 offen sc1
  s_mov_b32 s82, 0x3
  s_mov_b32 s83, 0x30
  v_cndmask_b32 v240, 0, v31, s[82:83]
  s_mov_b32 s82, 0xc
  s_nop 0
  s_mov_b32 s83, 0xc0
  v_cndmask_b32 v241, 0, v31, s[82:83]
  s_mov_b32 s82, 0x300
  s_mov_b32 s83, 0x3000
  v_cndmask_b32 v242, 0, v31, s[82:83]
  s_mov_b32 s82, 0xc00
  s_mov_b32 s83, 0xc000
  v_cndmask_b32 v243, 0, v31, s[82:83]
  s_mov_b32 s82, 0x30000
  s_mov_b32 s83, 0x300000
  v_cndmask_b32 v248, 0, v31, s[82:83]
  s_mov_b32 s82, 0xc0000
  s_mov_b32 s83, 0xc00000
  v_cndmask_b32 v249, 0, v31, s[82:83]
  s_mov_b32 s82, 0x3000000
  s_mov_b32 s83, 0x30000000
  v_cndmask_b32 v250, 0, v31, s[82:83]
  s_mov_b32 s82, 0xc000000
  s_mov_b32 s83, 0xc0000000
  v_cndmask_b32 v251, 0, v31, s[82:83]
  s_mov_b32 s44, 0
L33:
  buffer_load_dword v7, v253, s[16:19], s41 offen sc1
  s_waitcnt vmcnt(1)
  v_cmp_gt_i32_e64 vcc, 3, v30
  s_cbranch_vccz L34
  buffer_load_dword v30, v253, s[16:19], s41 offen sc1
  s_add_u32 s44, s44, 1
  s_cmp_gt_u32 s44, 200000
  s_cbranch_scc1 Lend
  s_waitcnt vmcnt(1)
  v_cmp_gt_i32_e64 vcc, 3, v7
  s_cbranch_vccnz L33
L34:
  s_cmp_eq_u32 s40, 0
  s_cbranch_scc1 L35
  buffer_inv sc1
  s_waitcnt vmcnt(0)
L35:
  s_nop 0
  buffer_load_dwordx4 a[100:103], v6, s[16:19], s98 offen sc1
  buffer_load_dwordx4 v[176:179], v1, s[16:19], s72 offen offset:0 sc1
  buffer_load_dwordx4 v[180:183], v1, s[16:19], s72 offen offset:1024 sc1
  buffer_load_dwordx4 v[184:187], v1, s[16:19], s72 offen offset:2048 sc1
  buffer_load_dwordx4 v[188:191], v1, s[16:19], s72 offen offset:3072 sc1
  s_add_u32 s98, s98, 16384
  buffer_load_dwordx4 a[104:107], v5, s[16:19], s98 offen sc1
  s_add_u32 s72, s72, 4096
  buffer_load_dwordx4 v[192:195], v1, s[16:19], s72 offen offset:0 sc1
  buffer_load_dwordx4 v[196:199], v1, s[16:19], s72 offen offset:1024 sc1
  s_waitcnt vmcnt(6)
  v_mfma_f32_32x32x16_bf16 v[96:111], a[4:7], v[176:179], 0
  buffer_load_dwordx4 v[200:203], v1, s[16:19], s72 offen offset:2048 sc1
  v_mfma_f32_32x32x16_bf16 v[80:95], a[0:3], v[176:179], 0
  buffer_load_dwordx4 v[204:207], v1, s[16:19], s72 offen offset:3072 sc1
  s_waitcnt vmcnt(7)
  v_mfma_f32_32x32x16_bf16 v[96:111], a[12:15], v[180:183], v[96:111]
  buffer_load_dwordx4 a[108:111], v6, s[16:19], s98 offen sc1
  s_add_u32 s72, s72, 4096
  buffer_load_dwordx4 v[208:211], v1, s[16:19], s72 offen offset:0 sc1
  v_mfma_f32_32x32x16_bf16 v[80:95], a[8:11], v[180:183], v[80:95]
  buffer_load_dwordx4 v[212:215], v1, s[16:19], s72 offen offset:1024 sc1
  s_waitcnt vmcnt(9)
  v_mfma_f32_32x32x16_bf16 v[96:111], a[20:23], v[184:187], v[96:111]
  buffer_load_dwordx4 v[216:219], v1, s[16:19], s72 offen offset:2048 sc1
  v_mfma_f32_32x32x16_bf16 v[80:95], a[16:19], v[184:187], v[80:95]
  buffer_load_dwordx4 v[220:223], v1, s[16:19], s72 offen offset:3072 sc1
  s_waitcnt vmcnt(10)
  v_mfma_f32_32x32x16_bf16 v[96:111], a[28:31], v[188:191], v[96:111]
  s_add_u32 s72, s72, 4096
  buffer_load_dwordx4 v[224:227], v1, s[16:19], s72 offen offset:0 sc1
  v_mfma_f32_32x32x16_bf16 v[80:95], a[24:27], v[188:191], v[80:95]
  s_waitcnt vmcnt(9)
  v_mfma_f32_32x32x16_bf16 v[96:111], a[36:39], v[192:195], v[96:111]
  buffer_load_dwordx4 v[228:231], v1, s[16:19], s72 offen offset:1024 sc1
  v_mfma_f32_32x32x16_bf16 v[80:95], a[32:35], v[192:195], v[80:95]
  s_waitcnt vmcnt(9)
  v_mfma_f32_32x32x16_bf16 v[96:111], a[44:47], v[196:199], v[96:111]
  buffer_load_dwordx4 v[232:235], v1, s[16:19], s73 offen offset:0 sc1
  v_mfma_f32_32x32x16_bf16 v[80:95], a[40:43], v[196:199], v[80:95]
  s_waitcnt vmcnt(9)
  v_mfma_f32_32x32x16_bf16 v[96:111], a[52:55], v[200:203], v[96:111]
  buffer_load_dwordx4 v[236:239], v1, s[16:19], s73 offen offset:1024 sc1
  v_mfma_f32_32x32x16_bf16 v[80:95], a[48:51], v[200:203], v[80:95]
  s_waitcnt vmcnt(9)
  v_mfma_f32_32x32x16_bf16 v[96:111], a[60:63], v[204:207], v[96:111]
  buffer_load_dwordx4 v[176:179], v1, s[16:19], s73 offen offset:2048 sc1
  v_mfma_f32_32x32x16_bf16 v[80:95], a[56:59], v[204:207], v[80:95]
  s_waitcnt vmcnt(8)
  v_mfma_f32_32x32x16_bf16 v[96:111], a[68:71], v[208:211], v[96:111]
  buffer_load_dwordx4 v[180:183], v1, s[16:19], s73 offen offset:3072 sc1
  v_mfma_f32_32x32x16_bf16 v[80:95], a[64:67], v[208:211], v[80:95]
  s_waitcnt vmcnt(8)
  v_mfma_f32_32x32x16_bf16 v[96:111], a[76:79], v[212:215], v[96:111]
  s_add_u32 s73, s73, 4096
  buffer_load_dwordx4 v[184:187], v1, s[16:19], s73 offen offset:0 sc1
  v_mfma_f32_32x32x16_bf16 v[80:95], a[72:75], v[212:215], v[80:95]
  s_waitcnt vmcnt(8)
  v_mfma_f32_32x32x16_bf16 v[96:111], a[84:87], v[216:219], v[96:111]
  buffer_load_dwordx4 v[188:191], v1, s[16:19], s73 offen offset:1024 sc1
  s_getpc_b64 s[82:83]
L36:
  s_lshl2_add_u32 s96, s34, s32
  v_lshl_add_u32 v7, s96, 1, v0
  v_lshlrev_b32 v7, 7, v7
  v_min_u32 v7, Lend-L36, v7
  s_mov_b64 exec, 3
  global_load_dword v7, v7, s[82:83]
  s_mov_b64 exec, -1
  v_mfma_f32_32x32x16_bf16 v[80:95], a[80:83], v[216:219], v[80:95]
  s_waitcnt vmcnt(9)
  v_mfma_f32_32x32x16_bf16 v[96:111], a[92:95], v[220:223], v[96:111]
  buffer_load_dwordx4 v[192:195], v1, s[16:19], s73 offen offset:2048 sc1
  v_mfma_f32_32x32x16_bf16 v[80:95], a[88:91], v[220:223], v[80:95]
  s_waitcnt vmcnt(9)
  v_mfma_f32_32x32x16_bf16 v[96:111], a[100:103], v[224:227], v[96:111]
  buffer_load_dwordx4 v[196:199], v1, s[16:19], s73 offen offset:3072 sc1
  v_mfma_f32_32x32x16_bf16 v[80:95], a[96:99], v[224:227], v[80:95]
  s_waitcnt vmcnt(9)
  v_mfma_f32_32x32x16_bf16 v[96:111], a[108:111], v[228:231], v[96:111]
  s_add_u32 s73, s73, 4096
  buffer_load_dwordx4 v[200:203], v1, s[16:19], s73 offen offset:0 sc1
  v_mfma_f32_32x32x16_bf16 v[80:95], a[104:107], v[228:231], v[80:95]
  s_waitcnt vmcnt(9)
  v_mfma_f32_32x32x16_bf16 v[128:143], a[4:7], v[232:235], 0
  buffer_load_dwordx4 v[204:207], v1, s[16:19], s73 offen offset:1024 sc1
  v_mfma_f32_32x32x16_bf16 v[112:127], a[0:3], v[232:235], 0
  s_waitcnt vmcnt(9)
  v_mfma_f32_32x32x16_bf16 v[128:143], a[12:15], v[236:239], v[128:143]
  buffer_load_dwordx4 v[208:211], v1, s[16:19], s73 offen offset:2048 sc1
  s_nop 1
  ds_write_b128 v2, v[96:99] offset:4096
  v_mfma_f32_32x32x16_bf16 v[112:127], a[8:11], v[236:239], v[112:127]
  ds_write_b128 v2, v[100:103] offset:5120
  s_waitcnt vmcnt(9)
  v_mfma_f32_32x32x16_bf16 v[128:143], a[20:23], v[176:179], v[128:143]
  buffer_load_dwordx4 v[212:215], v1, s[16:19], s73 offen offset:3072 sc1
  v_mfma_f32_32x32x16_bf16 v[112:127], a[16:19], v[176:179], v[112:127]
  ds_write_b128 v2, v[104:107] offset:6144
  s_waitcnt vmcnt(9)
  v_mfma_f32_32x32x16_bf16 v[128:143], a[28:31], v[180:183], v[128:143]
  s_add_u32 s73, s73, 4096
  buffer_load_dwordx4 v[216:219], v1, s[16:19], s73 offen offset:0 sc1
  ds_write_b128 v2, v[108:111] offset:7168
  v_mfma_f32_32x32x16_bf16 v[112:127], a[24:27], v[180:183], v[112:127]
  s_waitcnt vmcnt(9)
  v_mfma_f32_32x32x16_bf16 v[128:143], a[36:39], v[184:187], v[128:143]
  buffer_load_dwordx4 v[220:223], v1, s[16:19], s73 offen offset:1024 sc1
  ds_write_b128 v19, v[80:83] offset:0
  v_mfma_f32_32x32x16_bf16 v[112:127], a[32:35], v[184:187], v[112:127]
  ds_write_b128 v19, v[84:87] offset:1024
  s_waitcnt vmcnt(9)
  v_mfma_f32_32x32x16_bf16 v[128:143], a[44:47], v[188:191], v[128:143]
  buffer_load_dwordx4 v[224:227], v1, s[16:19], s74 offen offset:0 sc1
  v_mfma_f32_32x32x16_bf16 v[112:127], a[40:43], v[188:191], v[112:127]
  ds_write_b128 v19, v[88:91] offset:2048
  s_waitcnt vmcnt(8)
  v_mfma_f32_32x32x16_bf16 v[128:143], a[52:55], v[192:195], v[128:143]
  buffer_load_dwordx4 v[228:231], v1, s[16:19], s74 offen offset:1024 sc1
  ds_write_b128 v19, v[92:95] offset:3072
  v_mfma_f32_32x32x16_bf16 v[112:127], a[48:51], v[192:195], v[112:127]
  s_waitcnt lgkmcnt(0)
  s_barrier
  ds_read_b128 v[144:147], v18 offset:0
  ds_read_b128 v[148:151], v18 offset:1024
  s_waitcnt vmcnt(8)
  v_mfma_f32_32x32x16_bf16 v[128:143], a[60:63], v[196:199], v[128:143]
  buffer_load_dwordx4 v[232:235], v1, s[16:19], s74 offen offset:2048 sc1
  ds_read_b128 v[152:155], v18 offset:2048
  ds_read_b128 v[156:159], v18 offset:3072
  ds_read_b128 v[160:163], v18 offset:4096
  v_mfma_f32_32x32x16_bf16 v[112:127], a[56:59], v[196:199], v[112:127]
  ds_read_b128 v[164:167], v18 offset:5120
  ds_read_b128 v[168:171], v18 offset:6144
  ds_read_b128 v[172:175], v18 offset:7168
  s_waitcnt vmcnt(8)
  v_mfma_f32_32x32x16_bf16 v[128:143], a[68:71], v[200:203], v[128:143]
  buffer_load_dwordx4 v[236:239], v1, s[16:19], s74 offen offset:3072 sc1
  v_mfma_f32_32x32x16_bf16 v[112:127], a[64:67], v[200:203], v[112:127]
  s_waitcnt lgkmcnt(0)
  v_add_f32 v144, v144, v160
  v_add_f32 v145, v145, v161
  v_add_f32 v146, v146, v162
  s_waitcnt vmcnt(8)
  v_mfma_f32_32x32x16_bf16 v[128:143], a[76:79], v[204:207], v[128:143]
  s_add_u32 s74, s74, 4096
  buffer_load_dwordx4 v[176:179], v1, s[16:19], s74 offen offset:0 sc1
  v_add_f32 v147, v147, v163
  v_add_f32 v148, v148, v164
  v_add_f32_e64 v149, v149, v165
  v_mfma_f32_32x32x16_bf16 v[112:127], a[72:75], v[204:207], v[112:127]
  v_add_f32 v150, v150, v166
  v_add_f32 v151, v151, v167
  v_add_f32 v152, v152, v168
  v_add_f32_e64 v153, v153, v169
  s_waitcnt vmcnt(8)
  v_mfma_f32_32x32x16_bf16 v[128:143], a[84:87], v[208:211], v[128:143]
  buffer_load_dwordx4 v[180:183], v1, s[16:19], s74 offen offset:1024 sc1
  v_add_f32 v154, v154, v170
  v_add_f32 v155, v155, v171
  v_add_f32_e64 v156, v156, v172
  v_mfma_f32_32x32x16_bf16 v[112:127], a[80:83], v[208:211], v[112:127]
  v_add_f32 v157, v157, v173
  v_add_f32 v158, v158, v174
  v_add_f32 v159, v159, v175
  s_waitcnt vmcnt(8)
  v_mfma_f32_32x32x16_bf16 v[128:143], a[92:95], v[212:215], v[128:143]
  buffer_load_dwordx4 v[184:187], v1, s[16:19], s74 offen offset:2048 sc1
  v_mfma_f32_32x32x16_bf16 v[112:127], a[88:91], v[212:215], v[112:127]
  s_waitcnt vmcnt(8)
  v_mfma_f32_32x32x16_bf16 v[128:143], a[100:103], v[216:219], v[128:143]
  buffer_load_dwordx4 v[188:191], v1, s[16:19], s74 offen offset:3072 sc1
  v_mfma_f32_32x32x16_bf16 v[112:127], a[96:99], v[216:219], v[112:127]
  s_waitcnt vmcnt(8)
  v_mfma_f32_32x32x16_bf16 v[128:143], a[108:111], v[220:223], v[128:143]
  s_add_u32 s74, s74, 4096
  buffer_load_dwordx4 v[192:195], v1, s[16:19], s74 offen offset:0 sc1
  v_mfma_f32_32x32x16_bf16 v[112:127], a[104:107], v[220:223], v[112:127]
  s_waitcnt vmcnt(8)
  v_mfma_f32_32x32x16_bf16 v[96:111], a[4:7], v[224:227], 0
  buffer_load_dwordx4 v[196:199], v1, s[16:19], s74 offen offset:1024 sc1
  v_mfma_f32_32x32x16_bf16 v[80:95], a[0:3], v[224:227], 0
  s_waitcnt vmcnt(8)
  v_mfma_f32_32x32x16_bf16 v[96:111], a[12:15], v[228:231], v[96:111]
  buffer_load_dwordx4 v[200:203], v1, s[16:19], s74 offen offset:2048 sc1
  s_nop 1
  ds_write_b128 v18, v[128:131] offset:0
  v_mfma_f32_32x32x16_bf16 v[80:95], a[8:11], v[228:231], v[80:95]
  ds_write_b128 v18, v[132:135] offset:1024
  s_waitcnt vmcnt(8)
  v_mfma_f32_32x32x16_bf16 v[96:111], a[20:23], v[232:235], v[96:111]
  buffer_load_dwordx4 v[204:207], v1, s[16:19], s74 offen offset:3072 sc1
  v_mfma_f32_32x32x16_bf16 v[80:95], a[16:19], v[232:235], v[80:95]
  ds_write_b128 v18, v[136:139] offset:2048
  s_waitcnt vmcnt(8)
  v_mfma_f32_32x32x16_bf16 v[96:111], a[28:31], v[236:239], v[96:111]
  s_add_u32 s74, s74, 4096
  buffer_load_dwordx4 v[208:211], v1, s[16:19], s74 offen offset:0 sc1
  ds_write_b128 v18, v[140:143] offset:3072
  v_mfma_f32_32x32x16_bf16 v[80:95], a[24:27], v[236:239], v[80:95]
  s_waitcnt lgkmcnt(0)
  s_barrier
  ds_read_b128 v[160:163], v20 offset:0
  ds_read_b128 v[164:167], v20 offset:1024
  s_waitcnt vmcnt(8)
  v_mfma_f32_32x32x16_bf16 v[96:111], a[36:39], v[176:179], v[96:111]
  buffer_load_dwordx4 v[212:215], v1, s[16:19], s74 offen offset:1024 sc1
  ds_read_b128 v[168:171], v20 offset:2048
  ds_read_b128 v[172:175], v20 offset:3072
  v_add_f32_e64 v144, v144, v112
  v_mfma_f32_32x32x16_bf16 v[80:95], a[32:35], v[176:179], v[80:95]
  v_add_f32 v145, v145, v113
  v_add_f32 v146, v146, v114
  v_add_f32 v147, v147, v115
  v_add_f32_e64 v148, v148, v116
  s_waitcnt vmcnt(8)
  v_mfma_f32_32x32x16_bf16 v[96:111], a[44:47], v[180:183], v[96:111]
  buffer_load_dwordx4 v[216:219], v1, s[16:19], s75 offen offset:0 sc1
  v_add_f32 v149, v149, v117
  v_add_f32 v150, v150, v118
  v_add_f32_e64 v151, v151, v119
  v_mfma_f32_32x32x16_bf16 v[80:95], a[40:43], v[180:183], v[80:95]
  v_add_f32 v152, v152, v120
  v_add_f32 v153, v153, v121
  v_add_f32 v154, v154, v122
  v_add_f32_e64 v155, v155, v123
  s_waitcnt vmcnt(8)
  v_mfma_f32_32x32x16_bf16 v[96:111], a[52:55], v[184:187], v[96:111]
  buffer_load_dwordx4 v[220:223], v1, s[16:19], s75 offen offset:1024 sc1
  v_add_f32 v156, v156, v124
  v_add_f32 v157, v157, v125
  v_add_f32_e64 v158, v158, v126
  v_mfma_f32_32x32x16_bf16 v[80:95], a[48:51], v[184:187], v[80:95]
  v_add_f32 v159, v159, v127
  s_waitcnt lgkmcnt(0)
  v_add_f32 v144, v144, v160
  v_add_f32_e64 v145, v145, v161
  s_waitcnt vmcnt(8)
  v_mfma_f32_32x32x16_bf16 v[96:111], a[60:63], v[188:191], v[96:111]
  buffer_load_dwordx4 v[224:227], v1, s[16:19], s75 offen offset:2048 sc1
  v_add_f32 v146, v146, v162
  v_add_f32 v147, v147, v163
  v_add_f32_e64 v148, v148, v164
  v_mfma_f32_32x32x16_bf16 v[80:95], a[56:59], v[188:191], v[80:95]
  v_add_f32 v149, v149, v165
  v_add_f32 v150, v150, v166
  v_add_f32 v151, v151, v167
  v_add_f32_e64 v152, v152, v168
  s_waitcnt vmcnt(8)
  v_mfma_f32_32x32x16_bf16 v[96:111], a[68:71], v[192:195], v[96:111]
  buffer_load_dwordx4 v[228:231], v1, s[16:19], s75 offen offset:3072 sc1
  v_add_f32 v153, v153, v169
  v_add_f32 v154, v154, v170
  v_add_f32_e64 v155, v155, v171
  v_mfma_f32_32x32x16_bf16 v[80:95], a[64:67], v[192:195], v[80:95]
  v_add_f32 v156, v156, v172
  v_add_f32 v157, v157, v173
  v_add_f32 v158, v158, v174
  v_add_f32_e64 v159, v159, v175
  s_waitcnt vmcnt(8)
  v_mfma_f32_32x32x16_bf16 v[96:111], a[76:79], v[196:199], v[96:111]
  s_add_u32 s75, s75, 4096
  buffer_load_dwordx4 v[232:235], v1, s[16:19], s75 offen offset:0 sc1
  v_cvt_pk_bf16_f32 v160, v144, v145
  v_cvt_pk_bf16_f32 v161, v146, v147
  v_cvt_pk_bf16_f32 v162, v148, v149
  v_mfma_f32_32x32x16_bf16 v[80:95], a[72:75], v[196:199], v[80:95]
  v_cvt_pk_bf16_f32 v163, v150, v151
  v_cvt_pk_bf16_f32 v164, v152, v153
  v_cvt_pk_bf16_f32 v165, v154, v155
  v_cvt_pk_bf16_f32 v166, v156, v157
  s_waitcnt vmcnt(8)
  v_mfma_f32_32x32x16_bf16 v[96:111], a[84:87], v[200:203], v[96:111]
  buffer_load_dwordx4 v[236:239], v1, s[16:19], s75 offen offset:1024 sc1
  v_cvt_pk_bf16_f32 v167, v158, v159
  buffer_store_dwordx4 v[160:163], v1, s[12:15], s77 offen offset:0
  buffer_store_dwordx4 v[164:167], v1, s[12:15], s77 offen offset:1024
  v_mfma_f32_32x32x16_bf16 v[80:95], a[80:83], v[200:203], v[80:95]
  s_waitcnt vmcnt(10)
  v_mfma_f32_32x32x16_bf16 v[96:111], a[92:95], v[204:207], v[96:111]
  buffer_load_dwordx4 v[176:179], v1, s[16:19], s75 offen offset:2048 sc1
  v_mfma_f32_32x32x16_bf16 v[80:95], a[88:91], v[204:207], v[80:95]
  s_waitcnt vmcnt(10)
  v_mfma_f32_32x32x16_bf16 v[96:111], a[100:103], v[208:211], v[96:111]
  buffer_load_dwordx4 v[180:183], v1, s[16:19], s75 offen offset:3072 sc1
  v_mfma_f32_32x32x16_bf16 v[80:95], a[96:99], v[208:211], v[80:95]
  s_waitcnt vmcnt(10)
  v_mfma_f32_32x32x16_bf16 v[96:111], a[108:111], v[212:215], v[96:111]
  s_add_u32 s75, s75, 4096
  buffer_load_dwordx4 v[184:187], v1, s[16:19], s75 offen offset:0 sc1
  v_mfma_f32_32x32x16_bf16 v[80:95], a[104:107], v[212:215], v[80:95]
  s_waitcnt vmcnt(10)
  v_mfma_f32_32x32x16_bf16 v[128:143], a[4:7], v[216:219], 0
  buffer_load_dwordx4 v[188:191], v1, s[16:19], s75 offen offset:1024 sc1
  v_mfma_f32_32x32x16_bf16 v[112:127], a[0:3], v[216:219], 0
  s_waitcnt vmcnt(10)
  v_mfma_f32_32x32x16_bf16 v[128:143], a[12:15], v[220:223], v[128:143]
  buffer_load_dwordx4 v[192:195], v1, s[16:19], s75 offen offset:2048 sc1
  s_nop 1
  ds_write_b128 v2, v[96:99] offset:4096
  v_mfma_f32_32x32x16_bf16 v[112:127], a[8:11], v[220:223], v[112:127]
  ds_write_b128 v2, v[100:103] offset:5120
  s_waitcnt vmcnt(10)
  v_mfma_f32_32x32x16_bf16 v[128:143], a[20:23], v[224:227], v[128:143]
  buffer_load_dwordx4 v[196:199], v1, s[16:19], s75 offen offset:3072 sc1
  v_mov_b32_e64 v30, 4
  s_mov_b64 exec, 1
  s_cmp_lg_u32 s40, 0
  s_waitcnt vmcnt(6)
  s_cbranch_scc1 L37
  buffer_store_dword v30, off, s[16:19], s42
  s_branch L38
L37:
  buffer_wbl2 sc1
  s_waitcnt vmcnt(0)
  buffer_store_dword v30, off, s[16:19], s42 sc1
L38:
  s_mov_b64 exec, -1
  v_mfma_f32_32x32x16_bf16 v[112:127], a[16:19], v[224:227], v[112:127]
  ds_write_b128 v2, v[104:107] offset:6144
  v_mfma_f32_32x32x16_bf16 v[128:143], a[28:31], v[228:231], v[128:143]
  s_add_u32 s75, s75, 4096
  buffer_load_dwordx4 v[200:203], v1, s[16:19], s75 offen offset:0 sc1
  ds_write_b128 v2, v[108:111] offset:7168
  s_barrier
  v_mfma_f32_32x32x16_bf16 v[112:127], a[24:27], v[228:231], v[112:127]
  v_mfma_f32_32x32x16_bf16 v[128:143], a[36:39], v[232:235], v[128:143]
  buffer_load_dwordx4 v[204:207], v1, s[16:19], s75 offen offset:1024 sc1
  ds_write_b128 v19, v[80:83] offset:0
  v_mfma_f32_32x32x16_bf16 v[112:127], a[32:35], v[232:235], v[112:127]
  ds_write_b128 v19, v[84:87] offset:1024
  v_mfma_f32_32x32x16_bf16 v[128:143], a[44:47], v[236:239], v[128:143]
  v_mfma_f32_32x32x16_bf16 v[112:127], a[40:43], v[236:239], v[112:127]
  ds_write_b128 v19, v[88:91] offset:2048
  s_waitcnt vmcnt(8)
  v_mfma_f32_32x32x16_bf16 v[128:143], a[52:55], v[176:179], v[128:143]
  ds_write_b128 v19, v[92:95] offset:3072
  v_mfma_f32_32x32x16_bf16 v[112:127], a[48:51], v[176:179], v[112:127]
  s_waitcnt lgkmcnt(0)
  s_barrier
  ds_read_b128 v[144:147], v18 offset:0
  ds_read_b128 v[148:151], v18 offset:1024
  s_waitcnt vmcnt(7)
  v_mfma_f32_32x32x16_bf16 v[128:143], a[60:63], v[180:183], v[128:143]
  ds_read_b128 v[152:155], v18 offset:2048
  ds_read_b128 v[156:159], v18 offset:3072
  ds_read_b128 v[160:163], v18 offset:4096
  ds_read_b128 v[164:167], v18 offset:5120
  v_mfma_f32_32x32x16_bf16 v[112:127], a[56:59], v[180:183], v[112:127]
  ds_read_b128 v[168:171], v18 offset:6144
  ds_read_b128 v[172:175], v18 offset:7168
  ds_read_b32 v246, v25 offset:2560
  s_waitcnt vmcnt(6)
  v_mfma_f32_32x32x16_bf16 v[128:143], a[68:71], v[184:187], v[128:143]
  buffer_load_dword v31, v254, s[16:19], s41 offen sc1
  v_mfma_f32_32x32x16_bf16 v[112:127], a[64:67], v[184:187], v[112:127]
  s_waitcnt lgkmcnt(0)
  v_fmac_f32 v32, v144, v246
  v_fmac_f32_e64 v33, v145, v246
  s_waitcnt vmcnt(6)
  v_mfma_f32_32x32x16_bf16 v[128:143], a[76:79], v[188:191], v[128:143]
  v_fmac_f32 v34, v146, v246
  v_fmac_f32 v35, v147, v246
  v_fmac_f32 v36, v148, v246
  v_fmac_f32_e64 v37, v149, v246
  s_waitcnt vmcnt(5)
  v_mfma_f32_32x32x16_bf16 v[128:143], a[84:87], v[192:195], v[128:143]
  v_fmac_f32 v38, v150, v246
  v_fmac_f32 v39, v151, v246
  v_fmac_f32 v40, v152, v246
  v_fmac_f32_e64 v41, v153, v246
  s_waitcnt vmcnt(4)
  v_mfma_f32_32x32x16_bf16 v[128:143], a[92:95], v[196:199], v[128:143]
  v_fmac_f32 v42, v154, v246
  v_fmac_f32 v43, v155, v246
  v_fmac_f32 v44, v156, v246
  v_fmac_f32_e64 v45, v157, v246
  s_waitcnt vmcnt(2)
  v_mfma_f32_32x32x16_bf16 v[128:143], a[100:103], v[200:203], v[128:143]
  v_fmac_f32 v46, v158, v246
  v_fmac_f32 v47, v159, v246
  v_fmac_f32 v32, v160, v246
  v_fmac_f32_e64 v33, v161, v246
  s_waitcnt vmcnt(1)
  v_mfma_f32_32x32x16_bf16 v[128:143], a[108:111], v[204:207], v[128:143]
  s_waitcnt vmcnt(0)
  v_cmp_gt_i32 vcc, 4, v31
  s_cbranch_vccz L39
  s_mov_b32 s44, 0
L40:
  buffer_load_dword v31, v254, s[16:19], s41 offen sc1
  s_add_u32 s44, s44, 1
  s_cmp_gt_u32 s44, 200000
  s_cbranch_scc1 Lend
  s_waitcnt vmcnt(0)
  v_cmp_gt_i32_e64 vcc, 4, v31
  s_cbranch_vccnz L40
L39:
  s_cmp_eq_u32 s40, 0
  s_cbranch_scc1 L41
  buffer_inv sc1
  s_waitcnt vmcnt(0)
L41:
  buffer_load_dwordx4 v[80:83], v1, s[12:15], s76 offen offset:0 sc1
  buffer_load_dwordx4 v[84:87], v1, s[12:15], s76 offen offset:1024 sc1
  v_mfma_f32_32x32x16_bf16 v[112:127], a[72:75], v[188:191], v[112:127]
  v_fmac_f32 v34, v162, v246
  v_fmac_f32 v35, v163, v246
  v_fmac_f32 v36, v164, v246
  v_fmac_f32_e64 v37, v165, v246
  v_mfma_f32_32x32x16_bf16 v[112:127], a[80:83], v[192:195], v[112:127]
  ds_write_b128 v18, v[128:131] offset:0
  ds_write_b128 v18, v[132:135] offset:1024
  ds_write_b128 v18, v[136:139] offset:2048
  ds_write_b128 v18, v[140:143] offset:3072
  v_mfma_f32_32x32x16_bf16 v[112:127], a[88:91], v[196:199], v[112:127]
  s_waitcnt lgkmcnt(0)
  s_barrier
  ds_read_b128 v[208:211], v20 offset:0
  ds_read_b128 v[212:215], v20 offset:1024
  v_mfma_f32_32x32x16_bf16 v[112:127], a[96:99], v[200:203], v[112:127]
  ds_read_b128 v[216:219], v20 offset:2048
  ds_read_b128 v[220:223], v20 offset:3072
  v_fmac_f32 v38, v166, v246
  v_fmac_f32 v39, v167, v246
  v_mfma_f32_32x32x16_bf16 v[112:127], a[104:107], v[204:207], v[112:127]
  v_fmac_f32 v40, v168, v246
  v_fmac_f32 v41, v169, v246
  v_fmac_f32 v42, v170, v246
  v_fmac_f32_e64 v43, v171, v246
  s_waitcnt vmcnt(0)
  v_mfma_f32_32x32x16_bf16 v[112:127], v[240:243], v[80:83], v[112:127]
  v_mfma_f32_32x32x16_bf16 v[112:127], v[248:251], v[84:87], v[112:127]
  v_pk_fma_f32 v[44:45], v[172:173], v[246:247], v[44:45] op_sel_hi:[1,0,1]
  v_pk_fma_f32 v[46:47], v[174:175], v[246:247], v[46:47] op_sel_hi:[1,0,1]
  s_waitcnt lgkmcnt(3)
  v_pk_fma_f32 v[32:33], v[208:209], v[246:247], v[32:33] op_sel_hi:[1,0,1]
  v_pk_fma_f32 v[34:35], v[210:211], v[246:247], v[34:35] op_sel_hi:[1,0,1]
  s_waitcnt lgkmcnt(2)
  v_pk_fma_f32 v[36:37], v[212:213], v[246:247], v[36:37] op_sel_hi:[1,0,1]
  v_pk_fma_f32 v[38:39], v[214:215], v[246:247], v[38:39] op_sel_hi:[1,0,1]
  s_waitcnt lgkmcnt(1)
  v_pk_fma_f32 v[40:41], v[216:217], v[246:247], v[40:41] op_sel_hi:[1,0,1]
  v_pk_fma_f32 v[42:43], v[218:219], v[246:247], v[42:43] op_sel_hi:[1,0,1]
  s_waitcnt lgkmcnt(0)
  v_pk_fma_f32 v[44:45], v[220:221], v[246:247], v[44:45] op_sel_hi:[1,0,1]
  v_pk_fma_f32 v[46:47], v[222:223], v[246:247], v[46:47] op_sel_hi:[1,0,1]
  v_pk_fma_f32 v[32:33], v[112:113], v[246:247], v[32:33] op_sel_hi:[1,0,1]
  v_pk_fma_f32 v[34:35], v[114:115], v[246:247], v[34:35] op_sel_hi:[1,0,1]
  v_cvt_pk_bf16_f32 v176, v32, v33
  v_cvt_pk_bf16_f32 v177, v34, v35
  v_pk_fma_f32 v[36:37], v[116:117], v[246:247], v[36:37] op_sel_hi:[1,0,1]
  v_pk_fma_f32 v[38:39], v[118:119], v[246:247], v[38:39] op_sel_hi:[1,0,1]
  v_cvt_pk_bf16_f32 v178, v36, v37
  v_cvt_pk_bf16_f32 v179, v38, v39
  v_pk_fma_f32 v[40:41], v[120:121], v[246:247], v[40:41] op_sel_hi:[1,0,1]
  v_pk_fma_f32 v[42:43], v[122:123], v[246:247], v[42:43] op_sel_hi:[1,0,1]
  v_cvt_pk_bf16_f32 v180, v40, v41
  v_cvt_pk_bf16_f32 v181, v42, v43
  v_pk_fma_f32 v[44:45], v[124:125], v[246:247], v[44:45] op_sel_hi:[1,0,1]
  v_pk_fma_f32 v[46:47], v[126:127], v[246:247], v[46:47] op_sel_hi:[1,0,1]
  v_cvt_pk_bf16_f32 v182, v44, v45
  v_cvt_pk_bf16_f32 v183, v46, v47
  buffer_store_dwordx4 v[176:179], v1, s[12:15], s80 offen
  buffer_store_dwordx4 v[180:183], v1, s[12:15], s80 offen offset:1024
  v_dot2_f32_bf16 v248, v176, v252, 0
  v_dot2_f32_bf16 v250, v176, v176, 0
  v_dot2_f32_bf16 v248, v177, v252, v248
  v_dot2_f32_bf16 v250, v177, v177, v250
  v_dot2_f32_bf16 v248, v178, v252, v248
  v_dot2_f32_bf16 v250, v178, v178, v250
  v_dot2_f32_bf16 v248, v179, v252, v248
  v_dot2_f32_bf16 v250, v179, v179, v250
  v_dot2_f32_bf16 v248, v180, v252, v248
  v_dot2_f32_bf16 v250, v180, v180, v250
  v_dot2_f32_bf16 v248, v181, v252, v248
  v_dot2_f32_bf16 v250, v181, v181, v250
  v_dot2_f32_bf16 v248, v182, v252, v248
  v_dot2_f32_bf16 v250, v182, v182, v250
  v_dot2_f32_bf16 v248, v183, v252, v248
  v_dot2_f32_bf16 v250, v183, v183, v250
  s_nop 2
  v_permlane32_swap_b32 v248, v250
  v_add_f32_e64 v248, v248, v250
  buffer_store_dword v248, v12, s[16:19], s81 offen
  v_mov_b32_e64 v30, 6
  s_mov_b64 exec, 1
  s_cmp_lg_u32 s40, 0
  s_waitcnt vmcnt(0)
  s_cbranch_scc1 L42
  buffer_store_dword v30, off, s[16:19], s42
  s_branch L43
L42:
  buffer_wbl2 sc1
  s_waitcnt vmcnt(0)
  buffer_store_dword v30, off, s[16:19], s42 sc1
L43:
  s_mov_b64 exec, -1
  s_waitcnt lgkmcnt(0)
  s_barrier
  s_nop 0
  buffer_load_dword v30, v3, s[16:19], s41 offen sc1
  ds_read_b128 v[144:147], v1 offset:1024
  ds_read_b128 v[148:151], v1 offset:2048
  ds_read_b128 v[152:155], v1 offset:0
  ds_read_b128 v[156:159], v1 offset:4096
  ds_read_b128 v[160:163], v1 offset:5120
  s_lshl_b32 s72, s63, 15
  s_add_u32 s72, s72, 0
  s_lshl_b32 s73, s63, 12
  s_add_u32 s73, s73, 1572864
  s_mov_b32 s75, s72
  s_and_b32 s74, s71, 7
  s_lshl_b32 s74, s74, 12
  s_add_u32 s72, s75, s74
  s_mov_b32 s44, 0
L44:
  buffer_load_dword v7, v3, s[16:19], s41 offen sc1
  s_waitcnt vmcnt(1)
  v_cmp_gt_i32_e64 vcc, 6, v30
  s_cbranch_vccz L45
  buffer_load_dword v30, v3, s[16:19], s41 offen sc1
  s_add_u32 s44, s44, 1
  s_cmp_gt_u32 s44, 200000
  s_cbranch_scc1 Lend
  s_waitcnt vmcnt(1)
  v_cmp_gt_i32_e64 vcc, 6, v7
  s_cbranch_vccnz L44
L45:
  s_cmp_eq_u32 s40, 0
  s_cbranch_scc1 L46
  buffer_inv sc1
  s_waitcnt vmcnt(0)
L46:
  s_nop 0
  buffer_load_dwordx4 v[172:175], v1, s[12:15], s72 offen offset:0 sc1
  buffer_load_dwordx4 v[176:179], v1, s[12:15], s72 offen offset:1024 sc1
  buffer_load_dwordx4 v[180:183], v1, s[12:15], s72 offen offset:2048 sc1
  buffer_load_dwordx4 v[184:187], v1, s[12:15], s72 offen offset:3072 sc1
  s_add_u32 s74, s74, 4096
  s_and_b32 s74, s74, 0x7fff
  s_add_u32 s72, s75, s74
  buffer_load_dwordx4 v[188:191], v1, s[12:15], s72 offen offset:0 sc1
  s_waitcnt vmcnt(4) lgkmcnt(4)
  v_mfma_f32_32x32x16_bf16 v[96:111], v[172:175], v[144:147], 0
  ds_read_b128 v[164:167], v1 offset:3072
  buffer_load_dwordx4 v[192:195], v1, s[12:15], s72 offen offset:1024 sc1
  s_waitcnt lgkmcnt(4)
  v_mfma_f32_32x32x16_bf16 v[112:127], v[172:175], v[148:151], 0
  ds_read_b128 v[168:171], v1 offset:7168
  s_waitcnt lgkmcnt(4)
  v_mfma_f32_32x32x16_bf16 v[80:95], v[152:155], v[172:175], 0
  ds_read_b128 v[144:147], v1 offset:8192
  buffer_load_dwordx4 v[224:227], v13, s[16:19], s73 offen offset:0 sc1
  s_waitcnt vmcnt(5) lgkmcnt(4)
  v_mfma_f32_32x32x16_bf16 v[96:111], v[176:179], v[156:159], v[96:111]
  ds_read_b128 v[148:151], v1 offset:6144
  s_waitcnt lgkmcnt(4)
  v_mfma_f32_32x32x16_bf16 v[112:127], v[176:179], v[160:163], v[112:127]
  ds_read_b128 v[152:155], v1 offset:10240
  buffer_load_dwordx4 v[196:199], v1, s[12:15], s72 offen offset:2048 sc1
  s_waitcnt lgkmcnt(4)
  v_mfma_f32_32x32x16_bf16 v[80:95], v[164:167], v[176:179], v[80:95]
  ds_read_b128 v[156:159], v1 offset:11264
  s_waitcnt vmcnt(5) lgkmcnt(4)
  v_mfma_f32_32x32x16_bf16 v[96:111], v[180:183], v[168:171], v[96:111]
  ds_read_b128 v[160:163], v1 offset:9216
  buffer_load_dwordx4 v[200:203], v1, s[12:15], s72 offen offset:3072 sc1
  s_waitcnt lgkmcnt(4)
  v_mfma_f32_32x32x16_bf16 v[112:127], v[180:183], v[144:147], v[112:127]
  ds_read_b128 v[164:167], v1 offset:13312
  s_waitcnt lgkmcnt(4)
  v_mfma_f32_32x32x16_bf16 v[80:95], v[148:151], v[180:183], v[80:95]
  ds_read_b128 v[168:171], v1 offset:14336
  buffer_load_dwordx4 v[228:231], v13, s[16:19], s73 offen offset:512 sc1
  s_waitcnt vmcnt(6) lgkmcnt(4)
  v_mfma_f32_32x32x16_bf16 v[96:111], v[184:187], v[152:155], v[96:111]
  ds_read_b128 v[144:147], v1 offset:12288
  s_waitcnt lgkmcnt(4)
  v_mfma_f32_32x32x16_bf16 v[112:127], v[184:187], v[156:159], v[112:127]
  ds_read_b128 v[148:151], v1 offset:16384
  s_waitcnt lgkmcnt(4)
  v_mfma_f32_32x32x16_bf16 v[80:95], v[160:163], v[184:187], v[80:95]
  ds_read_b128 v[152:155], v1 offset:17408
  s_add_u32 s74, s74, 4096
  s_and_b32 s74, s74, 0x7fff
  s_add_u32 s72, s75, s74
  buffer_load_dwordx4 v[204:207], v1, s[12:15], s72 offen offset:0 sc1
  s_waitcnt vmcnt(6) lgkmcnt(4)
  v_mfma_f32_32x32x16_bf16 v[96:111], v[188:191], v[164:167], v[96:111]
  ds_read_b128 v[156:159], v1 offset:15360
  s_waitcnt lgkmcnt(4)
  v_mfma_f32_32x32x16_bf16 v[112:127], v[188:191], v[168:171], v[112:127]
  ds_read_b128 v[160:163], v1 offset:19456
  buffer_load_dwordx4 v[208:211], v1, s[12:15], s72 offen offset:1024 sc1
  s_waitcnt lgkmcnt(4)
  v_mfma_f32_32x32x16_bf16 v[80:95], v[144:147], v[188:191], v[80:95]
  ds_read_b128 v[164:167], v1 offset:20480
  s_waitcnt vmcnt(6) lgkmcnt(4)
  v_mfma_f32_32x32x16_bf16 v[96:111], v[192:195], v[148:151], v[96:111]
  ds_read_b128 v[168:171], v1 offset:18432
  buffer_load_dwordx4 v[212:215], v1, s[12:15], s72 offen offset:2048 sc1
  s_waitcnt lgkmcnt(4)
  v_mfma_f32_32x32x16_bf16 v[112:127], v[192:195], v[152:155], v[112:127]
  ds_read_b128 v[144:147], v1 offset:22528
  s_waitcnt lgkmcnt(4)
  v_mfma_f32_32x32x16_bf16 v[80:95], v[156:159], v[192:195], v[80:95]
  ds_read_b128 v[148:151], v1 offset:23552
  buffer_load_dwordx4 v[232:235], v13, s[16:19], s73 offen offset:1024 sc1
  s_waitcnt vmcnt(6) lgkmcnt(4)
  v_mfma_f32_32x32x16_bf16 v[96:111], v[196:199], v[160:163], v[96:111]
  ds_read_b128 v[152:155], v1 offset:21504
  s_waitcnt lgkmcnt(4)
  v_mfma_f32_32x32x16_bf16 v[112:127], v[196:199], v[164:167], v[112:127]
  ds_read_b128 v[156:159], v1 offset:25600
  s_waitcnt lgkmcnt(4)
  v_mfma_f32_32x32x16_bf16 v[80:95], v[168:171], v[196:199], v[80:95]
  ds_read_b128 v[160:163], v1 offset:26624
  buffer_load_dwordx4 v[236:239], v13, s[16:19], s73 offen offset:1536 sc1
  s_waitcnt vmcnt(6) lgkmcnt(4)
  v_mfma_f32_32x32x16_bf16 v[96:111], v[200:203], v[144:147], v[96:111]
  ds_read_b128 v[164:167], v1 offset:24576
  s_waitcnt lgkmcnt(4)
  v_mfma_f32_32x32x16_bf16 v[112:127], v[200:203], v[148:151], v[112:127]
  ds_read_b128 v[168:171], v1 offset:28672
  buffer_load_dwordx4 v[216:219], v1, s[12:15], s72 offen offset:3072 sc1
  s_waitcnt lgkmcnt(4)
  v_mfma_f32_32x32x16_bf16 v[80:95], v[152:155], v[200:203], v[80:95]
  ds_read_b128 v[144:147], v1 offset:29696
  s_waitcnt vmcnt(5) lgkmcnt(4)
  v_mfma_f32_32x32x16_bf16 v[96:111], v[204:207], v[156:159], v[96:111]
  ds_read_b128 v[148:151], v1 offset:27648
  s_add_u32 s74, s74, 4096
  s_and_b32 s74, s74, 0x7fff
  s_add_u32 s72, s75, s74
  buffer_load_dwordx4 v[220:223], v1, s[12:15], s72 offen offset:0 sc1
  s_waitcnt lgkmcnt(4)
  v_mfma_f32_32x32x16_bf16 v[112:127], v[204:207], v[160:163], v[112:127]
  ds_read_b128 v[152:155], v1 offset:31744
  s_waitcnt lgkmcnt(4)
  v_mfma_f32_32x32x16_bf16 v[80:95], v[164:167], v[204:207], v[80:95]
  ds_read_b128 v[156:159], v1 offset:32768
  buffer_load_dwordx4 v[172:175], v1, s[12:15], s72 offen offset:1024 sc1
  s_waitcnt vmcnt(3)
  s_waitcnt lgkmcnt(4)
  v_mfma_f32_32x32x16_bf16 v[96:111], v[208:211], v[168:171], v[96:111]
  ds_read_b128 v[160:163], v1 offset:30720
  v_add_f32 v224, v224, v232
  v_add_f32_e64 v225, v225, v233
  s_waitcnt lgkmcnt(4)
  v_mfma_f32_32x32x16_bf16 v[112:127], v[208:211], v[144:147], v[112:127]
  ds_read_b128 v[164:167], v1 offset:34816
  v_add_f32 v226, v226, v234
  v_add_f32_e64 v227, v227, v235
  s_waitcnt lgkmcnt(4)
  v_mfma_f32_32x32x16_bf16 v[80:95], v[148:151], v[208:211], v[80:95]
  ds_read_b128 v[168:171], v1 offset:35840
  buffer_load_dwordx4 v[176:179], v1, s[12:15], s72 offen offset:2048 sc1
  v_add_f32 v228, v228, v236
  v_add_f32_e64 v229, v229, v237
  s_waitcnt lgkmcnt(4)
  v_mfma_f32_32x32x16_bf16 v[96:111], v[212:215], v[152:155], v[96:111]
  ds_read_b128 v[144:147], v1 offset:33792
  v_add_f32 v230, v230, v238
  v_add_f32_e64 v231, v231, v239
  s_waitcnt lgkmcnt(4)
  v_mfma_f32_32x32x16_bf16 v[112:127], v[212:215], v[156:159], v[112:127]
  ds_read_b128 v[148:151], v1 offset:37888
  buffer_load_dwordx4 v[180:183], v1, s[12:15], s72 offen offset:3072 sc1
  v_add_f32 v224, v224, v228
  v_add_f32_e64 v225, v225, v229
  s_waitcnt lgkmcnt(4)
  v_mfma_f32_32x32x16_bf16 v[80:95], v[160:163], v[212:215], v[80:95]
  ds_read_b128 v[152:155], v1 offset:38912
  v_add_f32 v226, v226, v230
  v_add_f32_e64 v227, v227, v231
  s_waitcnt vmcnt(4) lgkmcnt(4)
  v_mfma_f32_32x32x16_bf16 v[96:111], v[216:219], v[164:167], v[96:111]
  ds_read_b128 v[156:159], v1 offset:36864
  s_add_u32 s74, s74, 4096
  s_and_b32 s74, s74, 0x7fff
  s_add_u32 s72, s75, s74
  buffer_load_dwordx4 v[184:187], v1, s[12:15], s72 offen offset:0 sc1
  v_add_f32 v224, v224, v226
  v_add_f32 v225, v225, v227
  s_waitcnt lgkmcnt(4)
  v_mfma_f32_32x32x16_bf16 v[112:127], v[216:219], v[168:171], v[112:127]
  ds_read_b128 v[160:163], v1 offset:40960
  v_mov_b32 v226, v224
  v_mov_b32_e64 v227, v225
  s_waitcnt lgkmcnt(4)
  v_mfma_f32_32x32x16_bf16 v[80:95], v[144:147], v[216:219], v[80:95]
  ds_read_b128 v[164:167], v1 offset:41984
  buffer_load_dwordx4 v[188:191], v1, s[12:15], s72 offen offset:1024 sc1
  v_permlane32_swap_b32 v224, v226
  v_permlane32_swap_b32_e64 v225, v227
  s_waitcnt vmcnt(5) lgkmcnt(4)
  v_mfma_f32_32x32x16_bf16 v[96:111], v[220:223], v[148:151], v[96:111]
  ds_read_b128 v[168:171], v1 offset:39936
  v_add_f32 v224, v224, v226
  v_add_f32_e64 v225, v225, v227
  s_waitcnt lgkmcnt(4)
  v_mfma_f32_32x32x16_bf16 v[112:127], v[220:223], v[152:155], v[112:127]
  ds_read_b128 v[144:147], v1 offset:44032
  v_mul_f32 v248, 0x3b000000, v224
  v_mul_f32 v250, 0x3b000000, v225
  s_waitcnt lgkmcnt(4)
  v_mfma_f32_32x32x16_bf16 v[80:95], v[156:159], v[220:223], v[80:95]
  ds_read_b128 v[148:151], v1 offset:45056
  buffer_load_dwordx4 v[192:195], v1, s[12:15], s72 offen offset:2048 sc1
  v_fma_f32 v250, -v248, v248, v250
  v_max_f32_e64 v250, 0, v250
  s_waitcnt vmcnt(5) lgkmcnt(4)
  v_mfma_f32_32x32x16_bf16 v[96:111], v[172:175], v[160:163], v[96:111]
  ds_read_b128 v[152:155], v1 offset:43008
  v_add_f32 v250, 0x3727c5ac, v250
  v_rsq_f32 v250, v250
  s_waitcnt lgkmcnt(4)
  v_mfma_f32_32x32x16_bf16 v[112:127], v[172:175], v[164:167], v[112:127]
  ds_read_b128 v[156:159], v1 offset:47104
  buffer_load_dwordx4 v[196:199], v1, s[12:15], s72 offen offset:3072 sc1
  v_cvt_pk_bf16_f32 v228, -v248, -v248
  v_and_b32 v229, 0xffff0000, v228
  s_waitcnt lgkmcnt(4)
  v_mfma_f32_32x32x16_bf16 v[80:95], v[168:171], v[172:175], v[80:95]
  ds_read_b128 v[160:163], v1 offset:48128
  v_add_f32 v229, v248, v229
  v_cvt_pk_bf16_f32 v229, -v229, -v248
  s_waitcnt vmcnt(5) lgkmcnt(4)
  v_mfma_f32_32x32x16_bf16 v[96:111], v[176:179], v[144:147], v[96:111]
  ds_read_b128 v[164:167], v1 offset:46080
  s_add_u32 s74, s74, 4096
  s_and_b32 s74, s74, 0x7fff
  s_add_u32 s72, s75, s74
  buffer_load_dwordx4 v[200:203], v1, s[12:15], s72 offen offset:0 sc1
  v_cndmask_b32 v252, 0, v228, s[52:53]
  v_cndmask_b32 v253, 0, v229, s[52:53]
  s_waitcnt lgkmcnt(4)
  v_mfma_f32_32x32x16_bf16 v[112:127], v[176:179], v[148:151], v[112:127]
  ds_read_b128 v[168:171], v10 offset:1024
  v_mov_b32 v254, 0
  v_mov_b32 v255, 0
  s_waitcnt lgkmcnt(4)
  v_mfma_f32_32x32x16_bf16 v[80:95], v[152:155], v[176:179], v[80:95]
  ds_read_b128 v[144:147], v10 offset:2048
  buffer_load_dwordx4 v[204:207], v1, s[12:15], s72 offen offset:1024 sc1
  ds_write_b32 v24, v250 offset:2048
  ds_read_b128 v[224:227], v23 offset:2048
  s_waitcnt vmcnt(6) lgkmcnt(6)
  v_mfma_f32_32x32x16_bf16 v[96:111], v[180:183], v[156:159], v[96:111]
  ds_read_b128 v[148:151], v10 offset:0
  ds_read_b128 v[228:231], v23 offset:2080
  ds_read_b128 v[232:235], v23 offset:2112
  s_waitcnt lgkmcnt(8)
  v_mfma_f32_32x32x16_bf16 v[112:127], v[180:183], v[160:163], v[112:127]
  ds_read_b128 v[152:155], v10 offset:4096
  ds_read_b128 v[236:239], v23 offset:2144
  s_waitcnt lgkmcnt(9)
  v_mfma_f32_32x32x16_bf16 v[80:95], v[164:167], v[180:183], v[80:95]
  ds_read_b128 v[156:159], v10 offset:5120
  buffer_load_dwordx4 v[208:211], v1, s[12:15], s72 offen offset:2048 sc1
  s_waitcnt vmcnt(6) lgkmcnt(9)
  v_mfma_f32_32x32x16_bf16 v[96:111], v[184:187], v[168:171], v[96:111]
  ds_read_b128 v[160:163], v10 offset:3072
  s_waitcnt lgkmcnt(9)
  v_mfma_f32_32x32x16_bf16 v[112:127], v[184:187], v[144:147], v[112:127]
  ds_read_b128 v[164:167], v10 offset:7168
  buffer_load_dwordx4 v[212:215], v1, s[12:15], s72 offen offset:3072 sc1
  s_waitcnt lgkmcnt(7)
  v_mfma_f32_32x32x16_bf16 v[80:95], v[148:151], v[184:187], v[80:95]
  ds_read_b128 v[168:171], v10 offset:8192
  s_waitcnt vmcnt(6) lgkmcnt(5)
  v_mfma_f32_32x32x16_bf16 v[96:111], v[188:191], v[152:155], v[96:111]
  ds_read_b128 v[144:147], v10 offset:6144
  s_add_u32 s74, s74, 4096
  s_and_b32 s74, s74, 0x7fff
  s_add_u32 s72, s75, s74
  buffer_load_dwordx4 v[216:219], v1, s[12:15], s72 offen offset:0 sc1
  s_waitcnt lgkmcnt(4)
  v_mfma_f32_32x32x16_bf16 v[112:127], v[188:191], v[156:159], v[112:127]
  ds_read_b64 v[148:149], v16 offset:256
  s_waitcnt lgkmcnt(4)
  v_mfma_f32_32x32x16_bf16 v[80:95], v[160:163], v[188:191], v[80:95]
  ds_read_b64 v[152:153], v16 offset:512
  buffer_load_dwordx4 v[220:223], v1, s[12:15], s72 offen offset:1024 sc1
  s_waitcnt vmcnt(7) lgkmcnt(4)
  v_mfma_f32_32x32x16_bf16 v[96:111], v[192:195], v[164:167], v[96:111]
  ds_read_b64 v[156:157], v16 offset:0
  s_waitcnt lgkmcnt(4)
  v_mfma_f32_32x32x16_bf16 v[112:127], v[192:195], v[168:171], v[112:127]
  ds_read_b128 v[160:163], v10 offset:10240
  s_waitcnt lgkmcnt(4)
  v_mfma_f32_32x32x16_bf16 v[80:95], v[144:147], v[192:195], v[80:95]
  ds_read_b128 v[164:167], v10 offset:11264
  buffer_load_dwordx4 v[172:175], v1, s[12:15], s72 offen offset:2048 sc1
  s_waitcnt lgkmcnt(4)
  v_mfma_f32_32x32x16_bf16 v[96:111], v[252:255], v[148:151], v[96:111]
  ds_read_b128 v[168:171], v10 offset:9216
  s_waitcnt lgkmcnt(4)
  v_mfma_f32_32x32x16_bf16 v[112:127], v[252:255], v[152:155], v[112:127]
  ds_read_b128 v[144:147], v10 offset:13312
  buffer_load_dwordx4 v[176:179], v1, s[12:15], s72 offen offset:3072 sc1
  s_waitcnt lgkmcnt(4)
  v_mfma_f32_32x32x16_bf16 v[80:95], v[156:159], v[252:255], v[80:95]
  ds_read_b128 v[148:151], v10 offset:16384
  s_waitcnt vmcnt(8) lgkmcnt(4)
  v_mfma_f32_32x32x16_bf16 v[96:111], v[196:199], v[160:163], v[96:111]
  ds_read_b128 v[152:155], v10 offset:19456
  s_add_u32 s74, s74, 4096
  s_and_b32 s74, s74, 0x7fff
  s_add_u32 s72, s75, s74
  buffer_load_dwordx4 v[180:183], v1, s[12:15], s72 offen offset:0 sc1
  s_waitcnt lgkmcnt(4)
  v_mfma_f32_32x32x16_bf16 v[112:127], v[196:199], v[164:167], v[112:127]
  ds_read_b128 v[156:159], v10 offset:22528
  s_waitcnt lgkmcnt(4)
  v_mfma_f32_32x32x16_bf16 v[80:95], v[168:171], v[196:199], v[80:95]
  ds_read_b128 v[160:163], v10 offset:25600
  buffer_load_dwordx4 v[184:187], v1, s[12:15], s72 offen offset:1024 sc1
  s_waitcnt vmcnt(9) lgkmcnt(4)
  v_mfma_f32_32x32x16_bf16 v[96:111], v[200:203], v[144:147], v[96:111]
  ds_read_b128 v[164:167], v10 offset:28672
  s_waitcnt vmcnt(8) lgkmcnt(4)
  v_mfma_f32_32x32x16_bf16 v[96:111], v[204:207], v[148:151], v[96:111]
  ds_read_b128 v[168:171], v10 offset:31744
  s_waitcnt vmcnt(7) lgkmcnt(4)
  v_mfma_f32_32x32x16_bf16 v[96:111], v[208:211], v[152:155], v[96:111]
  ds_read_b128 v[144:147], v10 offset:34816
  buffer_load_dwordx4 v[188:191], v1, s[12:15], s72 offen offset:2048 sc1
  s_waitcnt vmcnt(7) lgkmcnt(4)
  v_mfma_f32_32x32x16_bf16 v[96:111], v[212:215], v[156:159], v[96:111]
  ds_read_b128 v[148:151], v10 offset:37888
  s_waitcnt vmcnt(6) lgkmcnt(4)
  v_mfma_f32_32x32x16_bf16 v[96:111], v[216:219], v[160:163], v[96:111]
  ds_read_b128 v[152:155], v10 offset:40960
  buffer_load_dwordx4 v[192:195], v1, s[12:15], s72 offen offset:3072 sc1
  s_waitcnt vmcnt(6) lgkmcnt(4)
  v_mfma_f32_32x32x16_bf16 v[96:111], v[220:223], v[164:167], v[96:111]
  ds_read_b128 v[156:159], v10 offset:44032
  s_waitcnt vmcnt(5) lgkmcnt(4)
  v_mfma_f32_32x32x16_bf16 v[96:111], v[172:175], v[168:171], v[96:111]
  ds_read_b128 v[160:163], v10 offset:47104
  s_waitcnt vmcnt(4) lgkmcnt(4)
  v_mfma_f32_32x32x16_bf16 v[96:111], v[176:179], v[144:147], v[96:111]
  ds_read_b128 v[164:167], v10 offset:14336
  s_waitcnt vmcnt(3) lgkmcnt(4)
  v_mfma_f32_32x32x16_bf16 v[96:111], v[180:183], v[148:151], v[96:111]
  ds_read_b128 v[168:171], v10 offset:17408
  s_waitcnt vmcnt(2) lgkmcnt(4)
  v_mfma_f32_32x32x16_bf16 v[96:111], v[184:187], v[152:155], v[96:111]
  ds_read_b128 v[144:147], v10 offset:20480
  s_waitcnt vmcnt(1) lgkmcnt(4)
  v_mfma_f32_32x32x16_bf16 v[96:111], v[188:191], v[156:159], v[96:111]
  ds_read_b128 v[148:151], v10 offset:23552
  s_waitcnt vmcnt(0) lgkmcnt(4)
  v_mfma_f32_32x32x16_bf16 v[96:111], v[192:195], v[160:163], v[96:111]
  ds_read_b128 v[152:155], v10 offset:26624
  s_waitcnt lgkmcnt(4)
  v_mfma_f32_32x32x16_bf16 v[112:127], v[200:203], v[164:167], v[112:127]
  ds_read_b128 v[156:159], v10 offset:29696
  s_waitcnt lgkmcnt(4)
  v_mfma_f32_32x32x16_bf16 v[112:127], v[204:207], v[168:171], v[112:127]
  ds_read_b128 v[160:163], v10 offset:32768
  s_nop 4
  v_pk_fma_f32 v[96:97], v[96:97], v[224:225], s[48:49]
  v_pk_fma_f32 v[98:99], v[98:99], v[226:227], s[48:49]
  v_pk_fma_f32 v[100:101], v[100:101], v[228:229], s[48:49]
  v_pk_fma_f32 v[102:103], v[102:103], v[230:231], s[48:49]
  v_pk_fma_f32 v[104:105], v[104:105], v[232:233], s[48:49]
  s_waitcnt lgkmcnt(4)
  v_mfma_f32_32x32x16_bf16 v[112:127], v[208:211], v[144:147], v[112:127]
  ds_read_b128 v[164:167], v10 offset:35840
  v_pk_fma_f32 v[106:107], v[106:107], v[234:235], s[48:49]
  v_pk_fma_f32 v[108:109], v[108:109], v[236:237], s[48:49]
  v_pk_fma_f32 v[110:111], v[110:111], v[238:239], s[48:49]
  v_pk_mul_f32 v[128:129], v[96:97], s[50:51]
  v_pk_mul_f32 v[130:131], v[98:99], s[50:51]
  v_pk_mul_f32 v[132:133], v[100:101], s[50:51]
  s_waitcnt lgkmcnt(4)
  v_mfma_f32_32x32x16_bf16 v[112:127], v[212:215], v[148:151], v[112:127]
  s_nop 0
  ds_read_b128 v[168:171], v10 offset:38912
  v_pk_mul_f32 v[134:135], v[102:103], s[50:51]
  v_pk_mul_f32 v[136:137], v[104:105], s[50:51]
  v_pk_mul_f32 v[138:139], v[106:107], s[50:51]
  v_pk_mul_f32 v[140:141], v[108:109], s[50:51]
  v_pk_mul_f32 v[142:143], v[110:111], s[50:51]
  v_exp_f32_e64 v128, v128 clamp
  s_waitcnt lgkmcnt(4)
  v_mfma_f32_32x32x16_bf16 v[112:127], v[216:219], v[152:155], v[112:127]
  s_nop 0
  ds_read_b128 v[144:147], v10 offset:41984
  v_max_f32_e64 v96, s48, v96
  v_exp_f32_e64 v129, v129 clamp
  v_max_f32_e64 v97, s48, v97
  v_exp_f32_e64 v130, v130 clamp
  v_max_f32_e64 v98, s48, v98
  v_exp_f32_e64 v131, v131 clamp
  s_waitcnt lgkmcnt(4)
  v_mfma_f32_32x32x16_bf16 v[112:127], v[220:223], v[156:159], v[112:127]
  s_nop 0
  ds_read_b128 v[148:151], v10 offset:45056
  v_max_f32_e64 v99, s48, v99
  v_exp_f32_e64 v132, v132 clamp
  v_max_f32_e64 v100, s48, v100
  v_exp_f32_e64 v133, v133 clamp
  v_max_f32_e64 v101, s48, v101
  v_exp_f32_e64 v134, v134 clamp
  s_waitcnt lgkmcnt(4)
  v_mfma_f32_32x32x16_bf16 v[112:127], v[172:175], v[160:163], v[112:127]
  s_nop 0
  ds_read_b128 v[152:155], v10 offset:48128
  v_max_f32_e64 v102, s48, v102
  v_exp_f32_e64 v135, v135 clamp
  v_max_f32_e64 v103, s48, v103
  v_exp_f32_e64 v136, v136 clamp
  v_max_f32_e64 v104, s48, v104
  v_exp_f32_e64 v137, v137 clamp
  s_waitcnt lgkmcnt(4)
  v_mfma_f32_32x32x16_bf16 v[112:127], v[176:179], v[164:167], v[112:127]
  s_nop 0
  ds_read_b128 v[156:159], v10 offset:12288
  v_max_f32_e64 v105, s48, v105
  v_exp_f32_e64 v138, v138 clamp
  v_max_f32_e64 v106, s48, v106
  v_exp_f32_e64 v139, v139 clamp
  v_max_f32_e64 v107, s48, v107
  v_exp_f32_e64 v140, v140 clamp
  s_waitcnt lgkmcnt(4)
  v_mfma_f32_32x32x16_bf16 v[112:127], v[180:183], v[168:171], v[112:127]
  s_nop 0
  ds_read_b128 v[160:163], v10 offset:15360
  v_max_f32_e64 v108, s48, v108
  v_exp_f32_e64 v141, v141 clamp
  v_max_f32_e64 v109, s48, v109
  v_exp_f32_e64 v142, v142 clamp
  v_max_f32_e64 v110, s48, v110
  v_exp_f32_e64 v143, v143 clamp
  s_waitcnt lgkmcnt(4)
  v_mfma_f32_32x32x16_bf16 v[112:127], v[184:187], v[144:147], v[112:127]
  s_nop 0
  ds_read_b128 v[164:167], v10 offset:18432
  v_max_f32_e64 v111, s48, v111
  v_pk_add_f32 v[96:97], v[96:97], v[128:129]
  v_pk_add_f32 v[98:99], v[98:99], v[130:131]
  v_pk_add_f32 v[100:101], v[100:101], v[132:133]
  v_pk_add_f32 v[102:103], v[102:103], v[134:135]
  v_pk_add_f32 v[104:105], v[104:105], v[136:137]
  s_waitcnt lgkmcnt(4)
  v_mfma_f32_32x32x16_bf16 v[112:127], v[188:191], v[148:151], v[112:127]
  s_nop 0
  ds_read_b128 v[168:171], v10 offset:21504
  v_pk_add_f32 v[106:107], v[106:107], v[138:139]
  v_pk_add_f32 v[108:109], v[108:109], v[140:141]
  v_pk_add_f32 v[110:111], v[110:111], v[142:143]
  v_cvt_pk_bf16_f32 v128, v96, v97
  v_cvt_pk_bf16_f32 v129, v98, v99
  v_cvt_pk_bf16_f32 v130, v100, v101
  s_waitcnt lgkmcnt(4)
  v_mfma_f32_32x32x16_bf16 v[112:127], v[192:195], v[152:155], v[112:127]
  s_nop 0
  ds_read_b128 v[144:147], v10 offset:24576
  v_cvt_pk_bf16_f32 v131, v102, v103
  v_cvt_pk_bf16_f32 v132, v104, v105
  v_cvt_pk_bf16_f32 v133, v106, v107
  v_cvt_pk_bf16_f32 v134, v108, v109
  v_cvt_pk_bf16_f32 v135, v110, v111
  v_pk_add_f32 v[96:97], v[96:97], v[104:105]
  s_waitcnt lgkmcnt(4)
  v_mfma_f32_32x32x16_bf16 v[80:95], v[156:159], v[200:203], v[80:95]
  s_nop 0
  ds_read_b128 v[148:151], v10 offset:27648
  v_pk_add_f32 v[98:99], v[98:99], v[106:107]
  v_pk_add_f32 v[100:101], v[100:101], v[108:109]
  v_pk_add_f32 v[102:103], v[102:103], v[110:111]
  v_pk_add_f32 v[96:97], v[96:97], v[100:101]
  v_pk_add_f32 v[98:99], v[98:99], v[102:103]
  v_pk_mul_f32 v[112:113], v[112:113], v[224:225]
  s_waitcnt lgkmcnt(4)
  v_mfma_f32_32x32x16_bf16 v[80:95], v[160:163], v[204:207], v[80:95]
  s_nop 0
  ds_read_b128 v[152:155], v10 offset:30720
  v_pk_mul_f32 v[114:115], v[114:115], v[226:227]
  v_pk_mul_f32 v[116:117], v[116:117], v[228:229]
  v_pk_mul_f32 v[118:119], v[118:119], v[230:231]
  v_pk_mul_f32 v[120:121], v[120:121], v[232:233]
  v_pk_mul_f32 v[122:123], v[122:123], v[234:235]
  v_pk_mul_f32 v[124:125], v[124:125], v[236:237]
  s_waitcnt lgkmcnt(4)
  v_mfma_f32_32x32x16_bf16 v[80:95], v[164:167], v[208:211], v[80:95]
  s_nop 0
  ds_read_b128 v[156:159], v10 offset:33792
  v_pk_mul_f32 v[126:127], v[126:127], v[238:239]
  v_cvt_pk_bf16_f32 v136, v112, v113
  v_cvt_pk_bf16_f32 v137, v114, v115
  v_cvt_pk_bf16_f32 v138, v116, v117
  v_cvt_pk_bf16_f32 v139, v118, v119
  v_cvt_pk_bf16_f32 v140, v120, v121
  s_waitcnt lgkmcnt(4)
  v_mfma_f32_32x32x16_bf16 v[80:95], v[168:171], v[212:215], v[80:95]
  ds_read_b128 v[160:163], v10 offset:36864
  v_cvt_pk_bf16_f32 v141, v122, v123
  v_cvt_pk_bf16_f32 v142, v124, v125
  v_cvt_pk_bf16_f32 v143, v126, v127
  v_pk_add_f32 v[96:97], v[96:97], v[98:99]
  v_add_f32 v104, v96, v97
  v_mfma_f32_32x32x16_bf16 v[112:127], v[128:131], v[136:139], 0
  s_waitcnt lgkmcnt(4)
  v_mfma_f32_32x32x16_bf16 v[80:95], v[144:147], v[216:219], v[80:95]
  ds_read_b128 v[164:167], v10 offset:39936
  v_mfma_f32_32x32x16_bf16 v[112:127], v[132:135], v[140:143], v[112:127]
  v_mov_b32 v105, v104
  s_add_u32 s72, s70, 393216
  s_nop 0
  v_permlane32_swap_b32_e64 v104, v105
  s_waitcnt lgkmcnt(4)
  v_mfma_f32_32x32x16_bf16 v[80:95], v[148:151], v[220:223], v[80:95]
  ds_read_b128 v[168:171], v10 offset:43008
  v_add_f32_e64 v104, v104, v105
  ds_write_b32 v22, v104
  s_waitcnt lgkmcnt(5)
  v_mfma_f32_32x32x16_bf16 v[80:95], v[152:155], v[172:175], v[80:95]
  s_nop 0
  ds_read_b128 v[144:147], v10 offset:46080
  v_cndmask_b32 v112, v112, v120, s[58:59]
  v_cndmask_b32 v113, v113, v121, s[58:59]
  v_cndmask_b32 v114, v114, v122, s[58:59]
  v_cndmask_b32 v115, v115, v123, s[58:59]
  ds_write_b128 v21, v[112:115] offset:0
  s_waitcnt lgkmcnt(6)
  v_mfma_f32_32x32x16_bf16 v[80:95], v[156:159], v[176:179], v[80:95]
  v_cndmask_b32 v116, v116, v124, s[58:59]
  v_cndmask_b32 v117, v117, v125, s[58:59]
  v_cndmask_b32 v118, v118, v126, s[58:59]
  v_cndmask_b32 v119, v119, v127, s[58:59]
  ds_write_b128 v21, v[116:119] offset:16
  s_waitcnt lgkmcnt(6)
  v_mfma_f32_32x32x16_bf16 v[80:95], v[160:163], v[180:183], v[80:95]
  s_waitcnt lgkmcnt(5)
  v_mfma_f32_32x32x16_bf16 v[80:95], v[164:167], v[184:187], v[80:95]
  s_waitcnt lgkmcnt(4)
  v_mfma_f32_32x32x16_bf16 v[80:95], v[168:171], v[188:191], v[80:95]
  s_waitcnt lgkmcnt(2)
  v_mfma_f32_32x32x16_bf16 v[80:95], v[144:147], v[192:195], v[80:95]
  s_waitcnt lgkmcnt(0)
  s_barrier
  ds_read_b128 v[224:227], v26 offset:0
  ds_read_b128 v[228:231], v26 offset:2304
  ds_read_b128 v[232:235], v26 offset:4608
  ds_read_b128 v[236:239], v26 offset:6912
  s_nop 5
  v_pk_fma_f32 v[80:81], v[80:81], v[250:251], s[48:49] op_sel_hi:[1,0,1]
  v_pk_fma_f32 v[82:83], v[82:83], v[250:251], s[48:49] op_sel_hi:[1,0,1]
  v_pk_fma_f32 v[84:85], v[84:85], v[250:251], s[48:49] op_sel_hi:[1,0,1]
  v_pk_fma_f32 v[86:87], v[86:87], v[250:251], s[48:49] op_sel_hi:[1,0,1]
  v_pk_fma_f32 v[88:89], v[88:89], v[250:251], s[48:49] op_sel_hi:[1,0,1]
  v_pk_fma_f32 v[90:91], v[90:91], v[250:251], s[48:49] op_sel_hi:[1,0,1]
  v_pk_fma_f32 v[92:93], v[92:93], v[250:251], s[48:49] op_sel_hi:[1,0,1]
  v_pk_fma_f32 v[94:95], v[94:95], v[250:251], s[48:49] op_sel_hi:[1,0,1]
  v_pk_mul_f32 v[160:161], v[80:81], s[50:51]
  v_pk_mul_f32 v[162:163], v[82:83], s[50:51]
  v_pk_mul_f32 v[164:165], v[84:85], s[50:51]
  v_pk_mul_f32 v[166:167], v[86:87], s[50:51]
  v_pk_mul_f32 v[168:169], v[88:89], s[50:51]
  v_pk_mul_f32 v[170:171], v[90:91], s[50:51]
  s_waitcnt lgkmcnt(0)
  s_nop 0
  v_pk_add_f32 v[224:225], v[224:225], v[228:229]
  v_pk_add_f32 v[232:233], v[232:233], v[236:237]
  v_pk_add_f32 v[226:227], v[226:227], v[230:231]
  v_pk_add_f32 v[234:235], v[234:235], v[238:239]
  v_pk_add_f32 v[224:225], v[224:225], v[232:233]
  v_pk_add_f32 v[226:227], v[226:227], v[234:235]
  v_cvt_pk_bf16_f32 v228, v224, v225
  v_cvt_pk_bf16_f32 v229, v226, v227
  v_min_u32 v228, -2, v228
  v_min_u32_e64 v229, -2, v229
  s_mov_b32 exec_hi, s43
  buffer_store_dwordx2 v[228:229], v27, s[16:19], s72 offen sc1
  s_mov_b64 exec, -1
  s_xor_b32 s75, s36, 8
  s_lshr_b32 s77, s32, 1
  s_lshl1_add_u32 s72, s75, s77
  s_mul_i32 s72, s72, 10240
  s_add_u32 s72, s72, 393216
  s_and_b32 s79, s32, 1
  s_lshl4_add_u32 s74, s79, s72
  s_lshl_b32 s76, s79, 8
  s_add_u32 s72, s72, s76
  s_add_u32 s73, s72, 5120
  s_movk_i32 s78, 640
  v_lshrrev_b32 v238, 4, v0
  v_and_b32 v239, 0xf0, v1
  v_mad_u32_u24 v235, v238, s78, v239
  v_lshl_add_u32 v234, v238, 2, v239
  v_lshrrev_b32 v238, 2, v0
  v_and_b32 v239, 12, v28
  v_mad_u32_u24 v236, v238, s78, v239
  v_pk_mul_f32 v[172:173], v[92:93], s[50:51]
  v_pk_mul_f32 v[174:175], v[94:95], s[50:51]
  v_exp_f32_e64 v160, v160 clamp
  v_max_f32_e64 v80, s48, v80
  v_exp_f32_e64 v161, v161 clamp
  v_max_f32_e64 v81, s48, v81
  v_exp_f32_e64 v162, v162 clamp
  v_max_f32_e64 v82, s48, v82
  v_exp_f32_e64 v163, v163 clamp
  v_max_f32_e64 v83, s48, v83
  v_exp_f32_e64 v164, v164 clamp
  v_max_f32_e64 v84, s48, v84
  v_exp_f32_e64 v165, v165 clamp
  v_max_f32_e64 v85, s48, v85
  v_exp_f32_e64 v166, v166 clamp
  v_max_f32_e64 v86, s48, v86
  v_exp_f32_e64 v167, v167 clamp
  v_max_f32_e64 v87, s48, v87
  v_exp_f32_e64 v168, v168 clamp
  v_max_f32_e64 v88, s48, v88
  v_exp_f32_e64 v169, v169 clamp
  v_max_f32_e64 v89, s48, v89
  v_exp_f32_e64 v170, v170 clamp
  v_max_f32_e64 v90, s48, v90
  v_exp_f32_e64 v171, v171 clamp
  v_max_f32_e64 v91, s48, v91
  v_exp_f32_e64 v172, v172 clamp
  v_max_f32_e64 v92, s48, v92
  v_exp_f32_e64 v173, v173 clamp
  v_max_f32_e64 v93, s48, v93
  v_exp_f32_e64 v174, v174 clamp
  v_max_f32_e64 v94, s48, v94
  v_exp_f32_e64 v175, v175 clamp
  v_max_f32_e64 v95, s48, v95
  v_pk_add_f32 v[80:81], v[80:81], v[160:161]
  v_pk_add_f32 v[82:83], v[82:83], v[162:163]
  v_pk_add_f32 v[84:85], v[84:85], v[164:165]
  v_pk_add_f32 v[86:87], v[86:87], v[166:167]
  v_pk_add_f32 v[88:89], v[88:89], v[168:169]
  v_pk_add_f32 v[90:91], v[90:91], v[170:171]
  v_pk_add_f32 v[92:93], v[92:93], v[172:173]
  v_pk_add_f32 v[94:95], v[94:95], v[174:175]
  v_cvt_pk_bf16_f32 v152, v80, v81
  v_cvt_pk_bf16_f32 v153, v82, v83
  v_cvt_pk_bf16_f32 v154, v84, v85
  v_cvt_pk_bf16_f32 v155, v86, v87
  v_cvt_pk_bf16_f32 v156, v88, v89
  v_cvt_pk_bf16_f32 v157, v90, v91
  v_cvt_pk_bf16_f32 v158, v92, v93
  v_cvt_pk_bf16_f32 v159, v94, v95
  v_lshrrev_b32_e64 v238, 5, v0
  v_lshl_add_u32 v237, v238, 1, v239
  s_mul_i32 s77, s77, 544
  s_add_u32 s77, s77, 160768
  s_add_u32 s76, s76, s77
  v_add_u32 v234, s76, v234
  s_lshl4_add_u32 s77, s79, s77
  v_add_u32_e64 v237, s77, v237
  s_lshl4_add_u32 s78, s63, s75
  s_mul_i32 s78, s78, 7168
  s_add_u32 s78, s78, 8388608
  v_mov_b32 v232, 0x3f80
  v_mov_b32_e64 v233, 1.0
  s_mul_i32 s84, s46, 114688
  s_xor_b32 s85, s46, 1
  s_mul_i32 s85, s85, 114688
  s_mul_i32 s86, s32, 28672
  s_add_u32 s86, s86, 8388608
  s_add_u32 s84, s84, s86
  s_add_u32 s85, s85, s86
  s_add_u32 s80, s61, 0
  s_add_u32 s81, s62, 1572864
  v_mov_b32 v252, 0x3f803f80
  s_mul_i32 s96, s32, 3072
  v_add_u32 v5, s96, v1
  v_add_u32 v6, s96, v10
  ds_write_b128 v5, a[208:211] offset:0
  ds_write_b128 v5, a[212:215] offset:1024
  ds_write_b128 v5, a[216:219] offset:2048
  ds_write_b128 v5, a[220:223] offset:12288
  ds_write_b128 v5, a[112:115] offset:13312
  buffer_load_dword v192, v236, s[16:19], s74 offen offset:512 sc1
  buffer_load_dwordx4 v[176:179], v235, s[16:19], s72 offen offset:0 sc1
  buffer_load_dwordx4 v[180:183], v235, s[16:19], s72 offen offset:2560 sc1
  buffer_load_dwordx4 v[184:187], v235, s[16:19], s73 offen offset:0 sc1
  buffer_load_dwordx4 v[188:191], v235, s[16:19], s73 offen offset:2560 sc1
  ds_write_b128 v5, a[116:119] offset:14336
  ds_write_b128 v5, a[120:123] offset:24576
  ds_write_b128 v5, a[124:127] offset:25600
  ds_write_b128 v5, a[128:131] offset:26624
  ds_write_b128 v5, a[132:135] offset:36864
  s_mov_b32 s44, 0
L47:
  s_waitcnt vmcnt(4)
  v_lshlrev_b32_e64 v193, 16, v192
  v_and_b32 v194, 0xffff0000, v192
  s_waitcnt vmcnt(3)
  v_dot2_f32_bf16 v224, v176, v232, 0
  v_dot2_f32_bf16 v225, v176, v233, 0
  v_dot2_f32_bf16 v226, v177, v232, 0
  v_dot2_f32_bf16 v227, v177, v233, 0
  v_max3_u32 v30, v176, v177, v192
  v_permlane32_swap_b32 v193, v194
  v_dot2_f32_bf16 v228, v178, v232, 0
  v_dot2_f32_bf16 v229, v178, v233, 0
  v_dot2_f32_bf16 v230, v179, v232, 0
  v_dot2_f32_bf16 v231, v179, v233, 0
  v_max3_u32 v30, v178, v179, v30
  v_add_f32 v193, v193, v194
  s_waitcnt vmcnt(2)
  v_dot2_f32_bf16 v224, v180, v232, v224
  v_dot2_f32_bf16 v225, v180, v233, v225
  v_dot2_f32_bf16 v226, v181, v232, v226
  v_dot2_f32_bf16 v227, v181, v233, v227
  v_max3_u32 v30, v180, v181, v30
  v_add_f32_dpp v193, v193, v193 row_ror:4 row_mask:0xf bank_mask:0xf
  v_dot2_f32_bf16 v228, v182, v232, v228
  v_dot2_f32_bf16 v229, v182, v233, v229
  v_dot2_f32_bf16 v230, v183, v232, v230
  v_dot2_f32_bf16 v231, v183, v233, v231
  v_max3_u32 v30, v182, v183, v30
  v_add_f32_dpp v193, v193, v193 row_ror:8 row_mask:0xf bank_mask:0xf
  s_waitcnt vmcnt(1)
  v_dot2_f32_bf16 v224, v184, v232, v224
  v_dot2_f32_bf16 v225, v184, v233, v225
  v_dot2_f32_bf16 v226, v185, v232, v226
  v_dot2_f32_bf16 v227, v185, v233, v227
  v_max3_u32 v30, v184, v185, v30
  v_mov_b32 v194, v193
  v_dot2_f32_bf16 v228, v186, v232, v228
  v_dot2_f32_bf16 v229, v186, v233, v229
  v_dot2_f32_bf16 v230, v187, v232, v230
  v_dot2_f32_bf16 v231, v187, v233, v231
  v_max3_u32 v30, v186, v187, v30
  v_permlane16_swap_b32 v193, v194
  s_waitcnt vmcnt(0)
  v_dot2_f32_bf16 v224, v188, v232, v224
  v_dot2_f32_bf16 v225, v188, v233, v225
  v_dot2_f32_bf16 v226, v189, v232, v226
  v_dot2_f32_bf16 v227, v189, v233, v227
  v_max3_u32 v30, v188, v189, v30
  v_add_f32_e64 v193, v193, v194
  v_dot2_f32_bf16 v228, v190, v232, v228
  v_dot2_f32_bf16 v229, v190, v233, v229
  v_dot2_f32_bf16 v230, v191, v232, v230
  v_dot2_f32_bf16 v231, v191, v233, v231
  v_max3_u32 v30, v190, v191, v30
  v_cvt_pk_bf16_f32 v193, v193, v193
  v_cmp_eq_u32 vcc, -1, v30
  s_cbranch_vccnz L48
  ds_write_b16 v237, v193 offset:512
  v_permlane32_swap_b32 v224, v228
  v_permlane32_swap_b32 v225, v229
  v_permlane32_swap_b32 v226, v230
  v_permlane32_swap_b32 v227, v231
  v_pk_add_f32 v[224:225], v[224:225], v[228:229]
  v_pk_add_f32 v[226:227], v[226:227], v[230:231]
  s_nop 1
  v_permlane16_swap_b32 v224, v226
  v_permlane16_swap_b32_e64 v225, v227
  v_pk_add_f32 v[224:225], v[224:225], v[226:227]
  v_cvt_pk_bf16_f32 v224, v224, v225
  ds_write_b32 v234, v224
  s_waitcnt lgkmcnt(0)
  s_barrier
  ds_read_b128 v[160:163], v14 offset:0
  ds_read_b128 v[164:167], v14 offset:544
  s_waitcnt lgkmcnt(1)
  v_mfma_f32_32x32x16_bf16 v[80:95], v[160:163], v[152:155], 0
  s_waitcnt lgkmcnt(0)
  v_mfma_f32_32x32x16_bf16 v[96:111], v[164:167], v[156:159], 0
  s_nop 9
  v_add_f32 v88, s48, v88
  v_rcp_f32 v88, v88
  s_nop 0
  v_pk_mul_f32 v[80:81], v[80:81], v[88:89] op_sel_hi:[1,0]
  v_pk_mul_f32 v[82:83], v[82:83], v[88:89] op_sel_hi:[1,0]
  v_pk_mul_f32 v[84:85], v[84:85], v[88:89] op_sel_hi:[1,0]
  v_pk_mul_f32 v[86:87], v[86:87], v[88:89] op_sel_hi:[1,0]
  v_cvt_pk_bf16_f32 v92, v80, v81
  v_cvt_pk_bf16_f32 v93, v82, v83
  v_cvt_pk_bf16_f32 v94, v84, v85
  v_cvt_pk_bf16_f32 v95, v86, v87
  buffer_store_dwordx4 v[92:95], v1, s[16:19], s78 offen offset:0
  v_add_f32 v104, s48, v104
  v_rcp_f32_e64 v104, v104
  s_nop 0
  v_pk_mul_f32 v[96:97], v[96:97], v[104:105] op_sel_hi:[1,0]
  v_pk_mul_f32 v[98:99], v[98:99], v[104:105] op_sel_hi:[1,0]
  v_pk_mul_f32 v[100:101], v[100:101], v[104:105] op_sel_hi:[1,0]
  v_pk_mul_f32 v[102:103], v[102:103], v[104:105] op_sel_hi:[1,0]
  v_cvt_pk_bf16_f32 v108, v96, v97
  v_cvt_pk_bf16_f32 v109, v98, v99
  v_cvt_pk_bf16_f32 v110, v100, v101
  v_cvt_pk_bf16_f32 v111, v102, v103
  buffer_store_dwordx4 v[108:111], v1, s[16:19], s78 offen offset:1024
  ds_write_b128 v5, a[136:139] offset:37888
  ds_write_b128 v5, a[140:143] offset:38912
  ds_write_b128 v6, a[144:147] offset:0
  ds_write_b128 v6, a[148:151] offset:1024
  v_mov_b32_e64 v30, 7
  s_mov_b64 exec, 1
  s_cmp_lg_u32 s40, 0
  s_waitcnt vmcnt(0)
  s_cbranch_scc1 L49
  buffer_store_dword v30, off, s[16:19], s42
  s_branch L50
L49:
  buffer_wbl2 sc1
  s_waitcnt vmcnt(0)
  buffer_store_dword v30, off, s[16:19], s42 sc1
L50:
  s_mov_b64 exec, -1
  s_nop 0
  ds_write_b128 v6, a[152:155] offset:2048
  ds_write_b128 v6, a[156:159] offset:12288
  ds_write_b128 v6, a[160:163] offset:13312
  ds_write_b128 v6, a[164:167] offset:14336
  buffer_load_dword v30, v4, s[16:19], s41 offen sc1
  ds_write_b128 v6, a[168:171] offset:24576
  ds_write_b128 v6, a[172:175] offset:25600
  s_mov_b32 s44, 0
L51:
  buffer_load_dword v7, v4, s[16:19], s41 offen sc1
  s_waitcnt vmcnt(1)
  v_cmp_gt_i32 vcc, 7, v30
  s_cbranch_vccz L52
  buffer_load_dword v30, v4, s[16:19], s41 offen sc1
  s_add_u32 s44, s44, 1
  s_cmp_gt_u32 s44, 200000
  s_cbranch_scc1 Lend
  s_waitcnt vmcnt(1)
  v_cmp_gt_i32_e64 vcc, 7, v7
  s_cbranch_vccnz L51
L52:
  s_cmp_eq_u32 s40, 0
  s_cbranch_scc1 L53
  buffer_inv sc1
  s_waitcnt vmcnt(0)
L53:
  s_nop 0
  buffer_load_dwordx4 v[80:83], v1, s[16:19], s85 offen offset:0 sc1
  buffer_load_dwordx4 v[84:87], v1, s[16:19], s85 offen offset:1024 sc1
  s_add_u32 s85, s85, 7168
  buffer_load_dwordx4 v[88:91], v1, s[16:19], s85 offen offset:0 sc1
  buffer_load_dwordx4 v[92:95], v1, s[16:19], s85 offen offset:1024 sc1
  s_add_u32 s85, s85, 7168
  buffer_load_dwordx4 v[96:99], v1, s[16:19], s85 offen offset:0 sc1
  buffer_load_dwordx4 v[100:103], v1, s[16:19], s85 offen offset:1024 sc1
  s_waitcnt vmcnt(5)
  v_mfma_f32_32x32x16_bf16 v[160:175], a[228:231], v[80:83], 0
  s_add_u32 s85, s85, 7168
  buffer_load_dwordx4 v[104:107], v1, s[16:19], s85 offen offset:0 sc1
  v_mfma_f32_32x32x16_bf16 v[144:159], a[224:227], v[80:83], 0
  s_waitcnt vmcnt(5)
  v_mfma_f32_32x32x16_bf16 v[160:175], a[236:239], v[84:87], v[160:175]
  buffer_load_dwordx4 v[108:111], v1, s[16:19], s85 offen offset:1024 sc1
  v_mfma_f32_32x32x16_bf16 v[144:159], a[232:235], v[84:87], v[144:159]
  s_waitcnt vmcnt(5)
  v_mfma_f32_32x32x16_bf16 v[160:175], a[244:247], v[88:91], v[160:175]
  buffer_load_dwordx4 v[112:115], v1, s[16:19], s84 offen offset:0 sc1
  v_mfma_f32_32x32x16_bf16 v[144:159], a[240:243], v[88:91], v[144:159]
  s_waitcnt vmcnt(5)
  v_mfma_f32_32x32x16_bf16 v[160:175], a[252:255], v[92:95], v[160:175]
  buffer_load_dwordx4 v[116:119], v1, s[16:19], s84 offen offset:1024 sc1
  v_mfma_f32_32x32x16_bf16 v[144:159], a[248:251], v[92:95], v[144:159]
  s_waitcnt vmcnt(5)
  v_mfma_f32_32x32x16_bf16 v[160:175], v[52:55], v[96:99], v[160:175]
  s_add_u32 s84, s84, 7168
  buffer_load_dwordx4 v[120:123], v1, s[16:19], s84 offen offset:0 sc1
  v_mfma_f32_32x32x16_bf16 v[144:159], v[48:51], v[96:99], v[144:159]
  s_waitcnt vmcnt(5)
  v_mfma_f32_32x32x16_bf16 v[160:175], v[60:63], v[100:103], v[160:175]
  buffer_load_dwordx4 v[124:127], v1, s[16:19], s84 offen offset:1024 sc1
  v_mfma_f32_32x32x16_bf16 v[144:159], v[56:59], v[100:103], v[144:159]
  s_waitcnt vmcnt(5)
  v_mfma_f32_32x32x16_bf16 v[160:175], v[68:71], v[104:107], v[160:175]
  s_add_u32 s84, s84, 7168
  buffer_load_dwordx4 v[128:131], v1, s[16:19], s84 offen offset:0 sc1
  v_mfma_f32_32x32x16_bf16 v[144:159], v[64:67], v[104:107], v[144:159]
  s_waitcnt vmcnt(5)
  v_mfma_f32_32x32x16_bf16 v[160:175], v[76:79], v[108:111], v[160:175]
  buffer_load_dwordx4 v[132:135], v1, s[16:19], s84 offen offset:1024 sc1
  v_mfma_f32_32x32x16_bf16 v[144:159], v[72:75], v[108:111], v[144:159]
  s_waitcnt vmcnt(5)
  v_mfma_f32_32x32x16_bf16 v[192:207], a[228:231], v[112:115], 0
  s_add_u32 s84, s84, 7168
  buffer_load_dwordx4 v[136:139], v1, s[16:19], s84 offen offset:0 sc1
  v_mfma_f32_32x32x16_bf16 v[176:191], a[224:227], v[112:115], 0
  s_waitcnt vmcnt(5)
  v_mfma_f32_32x32x16_bf16 v[192:207], a[236:239], v[116:119], v[192:207]
  buffer_load_dwordx4 v[140:143], v1, s[16:19], s84 offen offset:1024 sc1
  s_nop 3
  ds_write_b128 v19, v[144:147] offset:0
  v_mfma_f32_32x32x16_bf16 v[176:191], a[232:235], v[116:119], v[176:191]
  ds_write_b128 v19, v[148:151] offset:1024
  s_waitcnt vmcnt(5)
  v_mfma_f32_32x32x16_bf16 v[192:207], a[244:247], v[120:123], v[192:207]
  ds_write_b128 v19, v[152:155] offset:2048
  v_mfma_f32_32x32x16_bf16 v[176:191], a[240:243], v[120:123], v[176:191]
  ds_write_b128 v19, v[156:159] offset:3072
  s_waitcnt vmcnt(4)
  v_mfma_f32_32x32x16_bf16 v[192:207], a[252:255], v[124:127], v[192:207]
  ds_write_b128 v2, v[160:163] offset:4096
  v_mfma_f32_32x32x16_bf16 v[176:191], a[248:251], v[124:127], v[176:191]
  ds_write_b128 v2, v[164:167] offset:5120
  s_waitcnt vmcnt(3)
  v_mfma_f32_32x32x16_bf16 v[192:207], v[52:55], v[128:131], v[192:207]
  ds_write_b128 v2, v[168:171] offset:6144
  s_waitcnt vmcnt(2)
  v_mfma_f32_32x32x16_bf16 v[192:207], v[60:63], v[132:135], v[192:207]
  ds_write_b128 v2, v[172:175] offset:7168
  s_waitcnt vmcnt(1)
  v_mfma_f32_32x32x16_bf16 v[192:207], v[68:71], v[136:139], v[192:207]
  s_waitcnt lgkmcnt(0)
  s_barrier
  ds_read_b128 v[144:147], v18 offset:0
  ds_read_b128 v[148:151], v18 offset:1024
  s_waitcnt vmcnt(0)
  v_mfma_f32_32x32x16_bf16 v[192:207], v[76:79], v[140:143], v[192:207]
  ds_read_b128 v[152:155], v18 offset:2048
  ds_read_b128 v[156:159], v18 offset:3072
  ds_read_b128 v[160:163], v18 offset:4096
  ds_read_b128 v[164:167], v18 offset:5120
  v_mfma_f32_32x32x16_bf16 v[176:191], v[48:51], v[128:131], v[176:191]
  ds_read_b128 v[168:171], v18 offset:6144
  ds_read_b128 v[172:175], v18 offset:7168
  s_waitcnt lgkmcnt(4)
  v_mfma_f32_32x32x16_bf16 v[176:191], v[56:59], v[132:135], v[176:191]
  s_nop 2
  ds_write_b128 v18, v[192:195] offset:0
  ds_write_b128 v18, v[196:199] offset:1024
  ds_write_b128 v18, v[200:203] offset:2048
  ds_write_b128 v18, v[204:207] offset:3072
  v_mfma_f32_32x32x16_bf16 v[176:191], v[64:67], v[136:139], v[176:191]
  v_mfma_f32_32x32x16_bf16 v[176:191], v[72:75], v[140:143], v[176:191]
  s_waitcnt lgkmcnt(4)
  v_pk_add_f32 v[32:33], v[32:33], v[144:145]
  v_pk_add_f32 v[34:35], v[34:35], v[146:147]
  v_pk_add_f32 v[36:37], v[36:37], v[148:149]
  v_pk_add_f32 v[38:39], v[38:39], v[150:151]
  v_pk_add_f32 v[40:41], v[40:41], v[152:153]
  v_pk_add_f32 v[42:43], v[42:43], v[154:155]
  v_pk_add_f32 v[44:45], v[44:45], v[156:157]
  v_pk_add_f32 v[46:47], v[46:47], v[158:159]
  s_waitcnt lgkmcnt(0)
  s_barrier
  ds_read_b128 v[208:211], v20 offset:0
  ds_read_b128 v[212:215], v20 offset:1024
  ds_read_b128 v[216:219], v20 offset:2048
  ds_read_b128 v[220:223], v20 offset:3072
  v_pk_add_f32 v[32:33], v[32:33], v[160:161]
  v_pk_add_f32 v[34:35], v[34:35], v[162:163]
  v_pk_add_f32 v[36:37], v[36:37], v[164:165]
  v_pk_add_f32 v[38:39], v[38:39], v[166:167]
  v_pk_add_f32 v[40:41], v[40:41], v[168:169]
  v_pk_add_f32 v[42:43], v[42:43], v[170:171]
  v_pk_add_f32 v[44:45], v[44:45], v[172:173]
  v_pk_add_f32 v[46:47], v[46:47], v[174:175]
  v_pk_add_f32 v[32:33], v[32:33], v[176:177]
  v_pk_add_f32 v[34:35], v[34:35], v[178:179]
  v_pk_add_f32 v[36:37], v[36:37], v[180:181]
  v_pk_add_f32 v[38:39], v[38:39], v[182:183]
  v_pk_add_f32 v[40:41], v[40:41], v[184:185]
  v_pk_add_f32 v[42:43], v[42:43], v[186:187]
  v_pk_add_f32 v[44:45], v[44:45], v[188:189]
  v_pk_add_f32 v[46:47], v[46:47], v[190:191]
  s_waitcnt lgkmcnt(3)
  v_pk_add_f32 v[32:33], v[32:33], v[208:209]
  v_pk_add_f32 v[34:35], v[34:35], v[210:211]
  v_cvt_pk_bf16_f32 v80, v32, v33
  v_cvt_pk_bf16_f32 v81, v34, v35
  s_waitcnt lgkmcnt(2)
  v_pk_add_f32 v[36:37], v[36:37], v[212:213]
  v_pk_add_f32 v[38:39], v[38:39], v[214:215]
  v_cvt_pk_bf16_f32 v82, v36, v37
  v_cvt_pk_bf16_f32 v83, v38, v39
  s_waitcnt lgkmcnt(1)
  v_pk_add_f32 v[40:41], v[40:41], v[216:217]
  v_pk_add_f32 v[42:43], v[42:43], v[218:219]
  v_cvt_pk_bf16_f32 v84, v40, v41
  v_cvt_pk_bf16_f32 v85, v42, v43
  s_waitcnt lgkmcnt(0)
  v_pk_add_f32 v[44:45], v[44:45], v[220:221]
  v_pk_add_f32 v[46:47], v[46:47], v[222:223]
  v_cvt_pk_bf16_f32 v86, v44, v45
  v_cvt_pk_bf16_f32 v87, v46, v47
  buffer_store_dwordx4 v[80:83], v1, s[12:15], s80 offen
  buffer_store_dwordx4 v[84:87], v1, s[12:15], s80 offen offset:1024
  v_dot2_f32_bf16 v248, v80, v252, 0
  v_dot2_f32_bf16 v250, v80, v80, 0
  v_dot2_f32_bf16 v248, v81, v252, v248
  v_dot2_f32_bf16 v250, v81, v81, v250
  v_dot2_f32_bf16 v248, v82, v252, v248
  v_dot2_f32_bf16 v250, v82, v82, v250
  v_dot2_f32_bf16 v248, v83, v252, v248
  v_dot2_f32_bf16 v250, v83, v83, v250
  v_dot2_f32_bf16 v248, v84, v252, v248
  v_dot2_f32_bf16 v250, v84, v84, v250
  v_dot2_f32_bf16 v248, v85, v252, v248
  v_dot2_f32_bf16 v250, v85, v85, v250
  v_dot2_f32_bf16 v248, v86, v252, v248
  v_dot2_f32_bf16 v250, v86, v86, v250
  v_dot2_f32_bf16 v248, v87, v252, v248
  v_dot2_f32_bf16 v250, v87, v87, v250
  s_nop 2
  v_permlane32_swap_b32 v248, v250
  v_add_f32_e64 v248, v248, v250
  buffer_store_dword v248, v12, s[16:19], s81 offen
  ds_write_b128 v6, a[176:179] offset:26624
  ds_write_b128 v6, a[180:183] offset:36864
  ds_write_b128 v6, a[184:187] offset:37888
  ds_write_b128 v6, a[188:191] offset:38912
  v_mov_b32_e64 v30, 8
  s_mov_b64 exec, 1
  s_cmp_lg_u32 s40, 0
  s_waitcnt vmcnt(0)
  s_cbranch_scc1 L54
  buffer_store_dword v30, off, s[16:19], s42
  s_branch L55
L54:
  buffer_wbl2 sc1
  s_waitcnt vmcnt(0)
  buffer_store_dword v30, off, s[16:19], s42 sc1
L55:
  s_mov_b64 exec, -1
  s_waitcnt lgkmcnt(0)
  s_barrier
  s_nop 0
  buffer_load_dword v30, v3, s[16:19], s41 offen sc1
  ds_read_b128 v[144:147], v1 offset:0
  ds_read_b128 v[148:151], v1 offset:1024
  ds_read_b128 v[152:155], v1 offset:2048
  ds_read_b128 v[156:159], v1 offset:3072
  ds_read_b128 v[160:163], v1 offset:4096
  s_lshl_b32 s72, s63, 15
  s_add_u32 s72, s72, 0
  s_lshl_b32 s73, s63, 12
  s_add_u32 s73, s73, 1572864
  s_mul_i32 s74, s63, 112
  s_mul_i32 s75, s36, 7
  s_add_u32 s74, s74, s75
  s_lshl_b32 s74, s74, 10
  s_add_u32 s74, s74, 8388608
  s_add_u32 s75, s74, 4096
  s_mov_b32 s44, 0
L56:
  buffer_load_dword v7, v3, s[16:19], s41 offen sc1
  s_waitcnt vmcnt(1)
  v_cmp_gt_i32 vcc, 8, v30
  s_cbranch_vccz L57
  buffer_load_dword v30, v3, s[16:19], s41 offen sc1
  s_add_u32 s44, s44, 1
  s_cmp_gt_u32 s44, 200000
  s_cbranch_scc1 Lend
  s_waitcnt vmcnt(1)
  v_cmp_gt_i32_e64 vcc, 8, v7
  s_cbranch_vccnz L56
L57:
  s_cmp_eq_u32 s40, 0
  s_cbranch_scc1 L58
  buffer_inv sc1
  s_waitcnt vmcnt(0)
L58:
  s_nop 0
  buffer_load_dwordx4 v[172:175], v1, s[12:15], s72 offen offset:0 sc1
  buffer_load_dwordx4 v[176:179], v1, s[12:15], s72 offen offset:1024 sc1
  buffer_load_dwordx4 v[180:183], v1, s[12:15], s72 offen offset:2048 sc1
  buffer_load_dwordx4 v[184:187], v1, s[12:15], s72 offen offset:3072 sc1
  s_add_u32 s72, s72, 4096
  buffer_load_dwordx4 v[188:191], v1, s[12:15], s72 offen offset:0 sc1
  s_waitcnt vmcnt(4) lgkmcnt(4)
  v_mfma_f32_32x32x16_bf16 v[80:95], v[144:147], v[172:175], 0
  ds_read_b128 v[164:167], v1 offset:5120
  buffer_load_dwordx4 v[192:195], v1, s[12:15], s72 offen offset:1024 sc1
  s_waitcnt lgkmcnt(4)
  v_mfma_f32_32x32x16_bf16 v[96:111], v[148:151], v[172:175], 0
  ds_read_b128 v[168:171], v1 offset:6144
  s_waitcnt lgkmcnt(4)
  v_mfma_f32_32x32x16_bf16 v[112:127], v[152:155], v[172:175], 0
  ds_read_b128 v[144:147], v1 offset:7168
  buffer_load_dwordx4 v[224:227], v13, s[16:19], s73 offen offset:0 sc1
  s_waitcnt vmcnt(5) lgkmcnt(4)
  v_mfma_f32_32x32x16_bf16 v[80:95], v[156:159], v[176:179], v[80:95]
  ds_read_b128 v[148:151], v1 offset:8192
  s_waitcnt lgkmcnt(4)
  v_mfma_f32_32x32x16_bf16 v[96:111], v[160:163], v[176:179], v[96:111]
  ds_read_b128 v[152:155], v10 offset:49152
  buffer_load_dwordx4 v[196:199], v1, s[12:15], s72 offen offset:2048 sc1
  s_waitcnt lgkmcnt(4)
  v_mfma_f32_32x32x16_bf16 v[112:127], v[164:167], v[176:179], v[112:127]
  ds_read_b128 v[156:159], v1 offset:9216
  s_waitcnt vmcnt(5) lgkmcnt(4)
  v_mfma_f32_32x32x16_bf16 v[80:95], v[168:171], v[180:183], v[80:95]
  ds_read_b128 v[160:163], v1 offset:10240
  buffer_load_dwordx4 v[200:203], v1, s[12:15], s72 offen offset:3072 sc1
  v_permlane16_swap_b32 v172, v176
  v_permlane16_swap_b32 v173, v177
  s_waitcnt lgkmcnt(4)
  v_mfma_f32_32x32x16_bf16 v[96:111], v[144:147], v[180:183], v[96:111]
  ds_read_b128 v[164:167], v1 offset:11264
  v_permlane16_swap_b32 v174, v178
  v_permlane16_swap_b32_e64 v175, v179
  s_waitcnt lgkmcnt(4)
  v_mfma_f32_32x32x16_bf16 v[112:127], v[148:151], v[180:183], v[112:127]
  ds_read_b128 v[168:171], v1 offset:12288
  buffer_load_dwordx4 v[228:231], v13, s[16:19], s73 offen offset:512 sc1
  s_waitcnt lgkmcnt(4)
  v_mfma_f32_16x16x32_bf16 v[128:131], v[152:155], v[172:175], 0
  v_mfma_f32_16x16x32_bf16 v[132:135], v[152:155], v[176:179], 0
  ds_read_b128 v[144:147], v1 offset:13312
  s_waitcnt vmcnt(6) lgkmcnt(4)
  v_mfma_f32_32x32x16_bf16 v[80:95], v[156:159], v[184:187], v[80:95]
  ds_read_b128 v[148:151], v1 offset:14336
  s_waitcnt lgkmcnt(4)
  v_mfma_f32_32x32x16_bf16 v[96:111], v[160:163], v[184:187], v[96:111]
  ds_read_b128 v[152:155], v10 offset:50176
  s_add_u32 s72, s72, 4096
  buffer_load_dwordx4 v[204:207], v1, s[12:15], s72 offen offset:0 sc1
  s_waitcnt lgkmcnt(4)
  v_mfma_f32_32x32x16_bf16 v[112:127], v[164:167], v[184:187], v[112:127]
  ds_read_b128 v[156:159], v1 offset:15360
  s_waitcnt vmcnt(6) lgkmcnt(4)
  v_mfma_f32_32x32x16_bf16 v[80:95], v[168:171], v[188:191], v[80:95]
  ds_read_b128 v[160:163], v1 offset:16384
  buffer_load_dwordx4 v[208:211], v1, s[12:15], s72 offen offset:1024 sc1
  v_permlane16_swap_b32 v180, v184
  v_permlane16_swap_b32 v181, v185
  s_waitcnt lgkmcnt(4)
  v_mfma_f32_32x32x16_bf16 v[96:111], v[144:147], v[188:191], v[96:111]
  ds_read_b128 v[164:167], v1 offset:17408
  v_permlane16_swap_b32 v182, v186
  v_permlane16_swap_b32_e64 v183, v187
  s_waitcnt lgkmcnt(4)
  v_mfma_f32_32x32x16_bf16 v[112:127], v[148:151], v[188:191], v[112:127]
  ds_read_b128 v[168:171], v1 offset:18432
  buffer_load_dwordx4 v[232:235], v13, s[16:19], s73 offen offset:1024 sc1
  s_waitcnt lgkmcnt(4)
  v_mfma_f32_16x16x32_bf16 v[128:131], v[152:155], v[180:183], v[128:131]
  v_mfma_f32_16x16x32_bf16 v[132:135], v[152:155], v[184:187], v[132:135]
  ds_read_b128 v[144:147], v1 offset:19456
  s_waitcnt vmcnt(7) lgkmcnt(4)
  v_mfma_f32_32x32x16_bf16 v[80:95], v[156:159], v[192:195], v[80:95]
  ds_read_b128 v[148:151], v1 offset:20480
  buffer_load_dwordx4 v[212:215], v1, s[12:15], s72 offen offset:2048 sc1
  s_waitcnt lgkmcnt(4)
  v_mfma_f32_32x32x16_bf16 v[96:111], v[160:163], v[192:195], v[96:111]
  ds_read_b128 v[152:155], v10 offset:51200
  s_waitcnt lgkmcnt(4)
  v_mfma_f32_32x32x16_bf16 v[112:127], v[164:167], v[192:195], v[112:127]
  ds_read_b128 v[156:159], v1 offset:21504
  s_waitcnt vmcnt(6) lgkmcnt(4)
  v_mfma_f32_32x32x16_bf16 v[80:95], v[168:171], v[196:199], v[80:95]
  ds_read_b128 v[160:163], v1 offset:22528
  buffer_load_dwordx4 v[236:239], v13, s[16:19], s73 offen offset:1536 sc1
  v_permlane16_swap_b32 v188, v192
  v_permlane16_swap_b32 v189, v193
  s_waitcnt lgkmcnt(4)
  v_mfma_f32_32x32x16_bf16 v[96:111], v[144:147], v[196:199], v[96:111]
  ds_read_b128 v[164:167], v1 offset:23552
  v_permlane16_swap_b32 v190, v194
  v_permlane16_swap_b32_e64 v191, v195
  s_waitcnt lgkmcnt(4)
  v_mfma_f32_32x32x16_bf16 v[112:127], v[148:151], v[196:199], v[112:127]
  ds_read_b128 v[168:171], v1 offset:24576
  buffer_load_dwordx4 v[216:219], v1, s[12:15], s72 offen offset:3072 sc1
  s_waitcnt lgkmcnt(4)
  v_mfma_f32_16x16x32_bf16 v[128:131], v[152:155], v[188:191], v[128:131]
  v_mfma_f32_16x16x32_bf16 v[132:135], v[152:155], v[192:195], v[132:135]
  ds_read_b128 v[144:147], v1 offset:25600
  s_waitcnt vmcnt(7) lgkmcnt(4)
  v_mfma_f32_32x32x16_bf16 v[80:95], v[156:159], v[200:203], v[80:95]
  ds_read_b128 v[148:151], v1 offset:26624
  s_add_u32 s72, s72, 4096
  buffer_load_dwordx4 v[220:223], v1, s[12:15], s72 offen offset:0 sc1
  s_waitcnt lgkmcnt(4)
  v_mfma_f32_32x32x16_bf16 v[96:111], v[160:163], v[200:203], v[96:111]
  ds_read_b128 v[152:155], v10 offset:52224
  s_waitcnt lgkmcnt(4)
  v_mfma_f32_32x32x16_bf16 v[112:127], v[164:167], v[200:203], v[112:127]
  ds_read_b128 v[156:159], v1 offset:27648
  buffer_load_dwordx4 v[172:175], v1, s[12:15], s72 offen offset:1024 sc1
  s_waitcnt vmcnt(7) lgkmcnt(4)
  v_mfma_f32_32x32x16_bf16 v[80:95], v[168:171], v[204:207], v[80:95]
  ds_read_b128 v[160:163], v1 offset:28672
  v_permlane16_swap_b32 v196, v200
  v_permlane16_swap_b32 v197, v201
  s_waitcnt lgkmcnt(4)
  v_mfma_f32_32x32x16_bf16 v[96:111], v[144:147], v[204:207], v[96:111]
  ds_read_b128 v[164:167], v1 offset:29696
  v_permlane16_swap_b32 v198, v202
  v_permlane16_swap_b32_e64 v199, v203
  s_waitcnt lgkmcnt(4)
  v_mfma_f32_32x32x16_bf16 v[112:127], v[148:151], v[204:207], v[112:127]
  ds_read_b128 v[168:171], v1 offset:30720
  buffer_load_dwordx4 v[176:179], v1, s[12:15], s72 offen offset:2048 sc1
  s_waitcnt lgkmcnt(4)
  v_mfma_f32_16x16x32_bf16 v[128:131], v[152:155], v[196:199], v[128:131]
  v_mfma_f32_16x16x32_bf16 v[132:135], v[152:155], v[200:203], v[132:135]
  ds_read_b128 v[144:147], v1 offset:31744
  s_waitcnt vmcnt(7) lgkmcnt(4)
  v_mfma_f32_32x32x16_bf16 v[80:95], v[156:159], v[208:211], v[80:95]
  ds_read_b128 v[148:151], v1 offset:32768
  buffer_load_dwordx4 v[180:183], v1, s[12:15], s72 offen offset:3072 sc1
  s_waitcnt lgkmcnt(4)
  v_mfma_f32_32x32x16_bf16 v[96:111], v[160:163], v[208:211], v[96:111]
  ds_read_b128 v[152:155], v10 offset:53248
  s_waitcnt lgkmcnt(4)
  v_mfma_f32_32x32x16_bf16 v[112:127], v[164:167], v[208:211], v[112:127]
  ds_read_b128 v[156:159], v1 offset:33792
  s_add_u32 s72, s72, 4096
  buffer_load_dwordx4 v[184:187], v1, s[12:15], s72 offen offset:0 sc1
  s_waitcnt vmcnt(7) lgkmcnt(4)
  v_mfma_f32_32x32x16_bf16 v[80:95], v[168:171], v[212:215], v[80:95]
  ds_read_b128 v[160:163], v1 offset:34816
  v_permlane16_swap_b32 v204, v208
  v_permlane16_swap_b32 v205, v209
  s_waitcnt lgkmcnt(4)
  v_mfma_f32_32x32x16_bf16 v[96:111], v[144:147], v[212:215], v[96:111]
  ds_read_b128 v[164:167], v1 offset:35840
  buffer_load_dwordx4 v[188:191], v1, s[12:15], s72 offen offset:1024 sc1
  v_permlane16_swap_b32 v206, v210
  v_permlane16_swap_b32_e64 v207, v211
  s_waitcnt lgkmcnt(4)
  v_mfma_f32_32x32x16_bf16 v[112:127], v[148:151], v[212:215], v[112:127]
  ds_read_b128 v[168:171], v1 offset:36864
  s_waitcnt lgkmcnt(4)
  v_mfma_f32_16x16x32_bf16 v[128:131], v[152:155], v[204:207], v[128:131]
  v_mfma_f32_16x16x32_bf16 v[132:135], v[152:155], v[208:211], v[132:135]
  ds_read_b128 v[144:147], v1 offset:37888
  s_waitcnt vmcnt(6) lgkmcnt(4)
  v_mfma_f32_32x32x16_bf16 v[80:95], v[156:159], v[216:219], v[80:95]
  ds_read_b128 v[148:151], v1 offset:38912
  buffer_load_dwordx4 v[192:195], v1, s[12:15], s72 offen offset:2048 sc1
  s_waitcnt lgkmcnt(4)
  v_mfma_f32_32x32x16_bf16 v[96:111], v[160:163], v[216:219], v[96:111]
  ds_read_b128 v[152:155], v10 offset:54272
  s_waitcnt lgkmcnt(4)
  v_mfma_f32_32x32x16_bf16 v[112:127], v[164:167], v[216:219], v[112:127]
  ds_read_b128 v[156:159], v1 offset:39936
  buffer_load_dwordx4 v[196:199], v1, s[12:15], s72 offen offset:3072 sc1
  s_waitcnt vmcnt(7) lgkmcnt(4)
  v_mfma_f32_32x32x16_bf16 v[80:95], v[168:171], v[220:223], v[80:95]
  ds_read_b128 v[160:163], v1 offset:40960
  v_permlane16_swap_b32 v212, v216
  v_permlane16_swap_b32 v213, v217
  s_waitcnt lgkmcnt(4)
  v_mfma_f32_32x32x16_bf16 v[96:111], v[144:147], v[220:223], v[96:111]
  ds_read_b128 v[164:167], v1 offset:41984
  s_add_u32 s72, s72, 4096
  buffer_load_dwordx4 v[200:203], v1, s[12:15], s72 offen offset:0 sc1
  v_permlane16_swap_b32 v214, v218
  v_permlane16_swap_b32_e64 v215, v219
  s_waitcnt lgkmcnt(4)
  v_mfma_f32_32x32x16_bf16 v[112:127], v[148:151], v[220:223], v[112:127]
  ds_read_b128 v[168:171], v1 offset:43008
  s_waitcnt lgkmcnt(4)
  v_mfma_f32_16x16x32_bf16 v[128:131], v[152:155], v[212:215], v[128:131]
  v_mfma_f32_16x16x32_bf16 v[132:135], v[152:155], v[216:219], v[132:135]
  ds_read_b128 v[144:147], v1 offset:44032
  s_waitcnt vmcnt(7) lgkmcnt(4)
  v_mfma_f32_32x32x16_bf16 v[80:95], v[156:159], v[172:175], v[80:95]
  ds_read_b128 v[148:151], v1 offset:45056
  buffer_load_dwordx4 v[204:207], v1, s[12:15], s72 offen offset:1024 sc1
  s_waitcnt lgkmcnt(4)
  v_mfma_f32_32x32x16_bf16 v[96:111], v[160:163], v[172:175], v[96:111]
  ds_read_b128 v[152:155], v10 offset:55296
  s_waitcnt lgkmcnt(4)
  v_mfma_f32_32x32x16_bf16 v[112:127], v[164:167], v[172:175], v[112:127]
  ds_read_b128 v[156:159], v1 offset:46080
  buffer_load_dwordx4 v[208:211], v1, s[12:15], s72 offen offset:2048 sc1
  s_waitcnt vmcnt(8) lgkmcnt(4)
  v_mfma_f32_32x32x16_bf16 v[80:95], v[168:171], v[176:179], v[80:95]
  ds_read_b128 v[160:163], v1 offset:47104
  v_add_f32 v224, v224, v232
  v_add_f32 v225, v225, v233
  v_permlane16_swap_b32 v220, v172
  v_permlane16_swap_b32 v221, v173
  s_waitcnt lgkmcnt(4)
  v_mfma_f32_32x32x16_bf16 v[96:111], v[144:147], v[176:179], v[96:111]
  ds_read_b128 v[164:167], v1 offset:48128
  buffer_load_dwordx4 v[212:215], v1, s[12:15], s72 offen offset:3072 sc1
  v_add_f32 v226, v226, v234
  v_add_f32 v227, v227, v235
  v_permlane16_swap_b32 v222, v174
  v_permlane16_swap_b32_e64 v223, v175
  s_waitcnt lgkmcnt(4)
  v_mfma_f32_32x32x16_bf16 v[112:127], v[148:151], v[176:179], v[112:127]
  ds_read_b128 v[168:171], v10 offset:0
  v_add_f32 v228, v228, v236
  v_add_f32_e64 v229, v229, v237
  s_waitcnt lgkmcnt(4)
  v_mfma_f32_16x16x32_bf16 v[128:131], v[152:155], v[220:223], v[128:131]
  v_mfma_f32_16x16x32_bf16 v[132:135], v[152:155], v[172:175], v[132:135]
  ds_read_b128 v[144:147], v10 offset:1024
  s_waitcnt vmcnt(8) lgkmcnt(4)
  v_mfma_f32_32x32x16_bf16 v[80:95], v[156:159], v[180:183], v[80:95]
  ds_read_b128 v[148:151], v10 offset:2048
  s_add_u32 s72, s72, 4096
  buffer_load_dwordx4 v[216:219], v1, s[12:15], s72 offen offset:0 sc1
  v_add_f32 v230, v230, v238
  v_add_f32 v231, v231, v239
  s_waitcnt lgkmcnt(4)
  v_mfma_f32_32x32x16_bf16 v[96:111], v[160:163], v[180:183], v[96:111]
  ds_read_b128 v[152:155], v10 offset:56320
  v_add_f32 v224, v224, v228
  v_add_f32_e64 v225, v225, v229
  s_waitcnt lgkmcnt(4)
  v_mfma_f32_32x32x16_bf16 v[112:127], v[164:167], v[180:183], v[112:127]
  ds_read_b128 v[156:159], v10 offset:3072
  buffer_load_dwordx4 v[220:223], v1, s[12:15], s72 offen offset:1024 sc1
  v_add_f32 v226, v226, v230
  v_add_f32_e64 v227, v227, v231
  s_waitcnt vmcnt(9) lgkmcnt(4)
  v_mfma_f32_32x32x16_bf16 v[80:95], v[168:171], v[184:187], v[80:95]
  ds_read_b128 v[160:163], v10 offset:4096
  v_add_f32 v224, v224, v226
  v_add_f32 v225, v225, v227
  v_permlane16_swap_b32 v176, v180
  v_permlane16_swap_b32_e64 v177, v181
  s_waitcnt lgkmcnt(4)
  v_mfma_f32_32x32x16_bf16 v[96:111], v[144:147], v[184:187], v[96:111]
  ds_read_b128 v[164:167], v10 offset:5120
  buffer_load_dwordx4 v[172:175], v1, s[12:15], s72 offen offset:2048 sc1
  v_mov_b32 v226, v224
  v_mov_b32 v227, v225
  v_permlane16_swap_b32 v178, v182
  v_permlane16_swap_b32_e64 v179, v183
  s_waitcnt lgkmcnt(4)
  v_mfma_f32_32x32x16_bf16 v[112:127], v[148:151], v[184:187], v[112:127]
  ds_read_b128 v[168:171], v10 offset:6144
  v_permlane32_swap_b32 v224, v226
  v_permlane32_swap_b32_e64 v225, v227
  s_waitcnt lgkmcnt(4)
  v_mfma_f32_16x16x32_bf16 v[128:131], v[152:155], v[176:179], v[128:131]
  v_mfma_f32_16x16x32_bf16 v[132:135], v[152:155], v[180:183], v[132:135]
  ds_read_b128 v[144:147], v10 offset:7168
  s_waitcnt vmcnt(9) lgkmcnt(4)
  v_mfma_f32_32x32x16_bf16 v[80:95], v[156:159], v[188:191], v[80:95]
  ds_read_b128 v[148:151], v10 offset:8192
  buffer_load_dwordx4 v[176:179], v1, s[12:15], s72 offen offset:3072 sc1
  v_add_f32 v224, v224, v226
  v_add_f32 v225, v225, v227
  s_waitcnt lgkmcnt(4)
  v_mfma_f32_32x32x16_bf16 v[96:111], v[160:163], v[188:191], v[96:111]
  ds_read_b128 v[152:155], v10 offset:57344
  v_mul_f32 v248, 0x3b000000, v224
  v_mul_f32 v250, 0x3b000000, v225
  s_waitcnt lgkmcnt(4)
  v_mfma_f32_32x32x16_bf16 v[112:127], v[164:167], v[188:191], v[112:127]
  ds_read_b128 v[156:159], v10 offset:9216
  s_add_u32 s72, s72, 4096
  buffer_load_dwordx4 v[180:183], v1, s[12:15], s72 offen offset:0 sc1
  v_fma_f32 v250, -v248, v248, v250
  v_max_f32_e64 v250, 0, v250
  s_waitcnt vmcnt(10) lgkmcnt(4)
  v_mfma_f32_32x32x16_bf16 v[80:95], v[168:171], v[192:195], v[80:95]
  ds_read_b128 v[160:163], v10 offset:10240
  v_add_f32 v250, 0x3727c5ac, v250
  v_rsq_f32 v250, v250
  v_permlane16_swap_b32 v184, v188
  v_permlane16_swap_b32 v185, v189
  s_waitcnt lgkmcnt(4)
  v_mfma_f32_32x32x16_bf16 v[96:111], v[144:147], v[192:195], v[96:111]
  ds_read_b128 v[164:167], v10 offset:11264
  v_cvt_pk_bf16_f32 v228, -v248, -v248
  v_and_b32 v229, 0xffff0000, v228
  v_permlane16_swap_b32 v186, v190
  v_permlane16_swap_b32_e64 v187, v191
  s_waitcnt lgkmcnt(4)
  v_mfma_f32_32x32x16_bf16 v[112:127], v[148:151], v[192:195], v[112:127]
  ds_read_b128 v[168:171], v10 offset:12288
  v_add_f32_e64 v229, v248, v229
  v_cvt_pk_bf16_f32 v229, -v229, -v248
  s_waitcnt lgkmcnt(4)
  v_mfma_f32_16x16x32_bf16 v[128:131], v[152:155], v[184:187], v[128:131]
  v_mfma_f32_16x16x32_bf16 v[132:135], v[152:155], v[188:191], v[132:135]
  ds_read_b128 v[144:147], v10 offset:13312
  s_waitcnt vmcnt(9) lgkmcnt(4)
  v_mfma_f32_32x32x16_bf16 v[80:95], v[156:159], v[196:199], v[80:95]
  ds_read_b128 v[148:151], v10 offset:14336
  buffer_load_dwordx4 v[184:187], v1, s[12:15], s72 offen offset:1024 sc1
  v_cndmask_b32 v252, 0, v228, s[52:53]
  v_cndmask_b32 v253, 0, v229, s[52:53]
  s_waitcnt lgkmcnt(4)
  v_mfma_f32_32x32x16_bf16 v[96:111], v[160:163], v[196:199], v[96:111]
  ds_read_b128 v[152:155], v10 offset:58368
  v_mov_b32 v254, 0
  v_mov_b32 v255, 0
  s_waitcnt lgkmcnt(4)
  v_mfma_f32_32x32x16_bf16 v[112:127], v[164:167], v[196:199], v[112:127]
  ds_read_b128 v[156:159], v10 offset:15360
  buffer_load_dwordx4 v[188:191], v1, s[12:15], s72 offen offset:2048 sc1
  v_cndmask_b32 v240, 0, v228, s[54:55]
  v_cndmask_b32 v241, 0, v229, s[54:55]
  s_waitcnt vmcnt(10) lgkmcnt(4)
  v_mfma_f32_32x32x16_bf16 v[80:95], v[168:171], v[200:203], v[80:95]
  ds_read_b128 v[160:163], v10 offset:16384
  v_mov_b32 v242, 0
  v_mov_b32 v243, 0
  v_permlane16_swap_b32 v192, v196
  v_permlane16_swap_b32 v193, v197
  s_waitcnt lgkmcnt(4)
  v_mfma_f32_32x32x16_bf16 v[96:111], v[144:147], v[200:203], v[96:111]
  ds_read_b128 v[164:167], v10 offset:17408
  v_cndmask_b32 v244, 0, v228, s[56:57]
  v_cndmask_b32 v245, 0, v229, s[56:57]
  v_permlane16_swap_b32 v194, v198
  v_permlane16_swap_b32_e64 v195, v199
  s_waitcnt lgkmcnt(4)
  v_mfma_f32_32x32x16_bf16 v[112:127], v[148:151], v[200:203], v[112:127]
  ds_read_b128 v[168:171], v10 offset:18432
  v_mov_b32 v246, 0
  v_mov_b32_e64 v247, 0
  s_waitcnt lgkmcnt(4)
  v_mfma_f32_16x16x32_bf16 v[128:131], v[152:155], v[192:195], v[128:131]
  v_mfma_f32_16x16x32_bf16 v[132:135], v[152:155], v[196:199], v[132:135]
  ds_read_b128 v[144:147], v10 offset:19456
  s_waitcnt vmcnt(9) lgkmcnt(4)
  v_mfma_f32_32x32x16_bf16 v[80:95], v[156:159], v[204:207], v[80:95]
  ds_read_b128 v[148:151], v10 offset:20480
  buffer_load_dwordx4 v[192:195], v1, s[12:15], s72 offen offset:3072 sc1
  ds_write_b32 v24, v250 offset:2560
  s_waitcnt lgkmcnt(5)
  v_mfma_f32_32x32x16_bf16 v[96:111], v[160:163], v[204:207], v[96:111]
  ds_read_b128 v[152:155], v10 offset:59392
  s_waitcnt lgkmcnt(5)
  v_mfma_f32_32x32x16_bf16 v[112:127], v[164:167], v[204:207], v[112:127]
  ds_read_b128 v[156:159], v10 offset:21504
  s_waitcnt vmcnt(9) lgkmcnt(5)
  v_mfma_f32_32x32x16_bf16 v[80:95], v[168:171], v[208:211], v[80:95]
  ds_read_b128 v[160:163], v10 offset:22528
  v_permlane16_swap_b32 v200, v204
  v_permlane16_swap_b32_e64 v201, v205
  s_waitcnt lgkmcnt(5)
  v_mfma_f32_32x32x16_bf16 v[96:111], v[144:147], v[208:211], v[96:111]
  ds_read_b128 v[164:167], v10 offset:23552
  v_permlane16_swap_b32 v202, v206
  v_permlane16_swap_b32_e64 v203, v207
  s_waitcnt lgkmcnt(5)
  v_mfma_f32_32x32x16_bf16 v[112:127], v[148:151], v[208:211], v[112:127]
  ds_read_b128 v[168:171], v10 offset:24576
  s_waitcnt lgkmcnt(4)
  v_mfma_f32_16x16x32_bf16 v[128:131], v[152:155], v[200:203], v[128:131]
  v_mfma_f32_16x16x32_bf16 v[132:135], v[152:155], v[204:207], v[132:135]
  ds_read_b128 v[144:147], v10 offset:25600
  s_waitcnt vmcnt(8) lgkmcnt(4)
  v_mfma_f32_32x32x16_bf16 v[80:95], v[156:159], v[212:215], v[80:95]
  ds_read_b128 v[148:151], v10 offset:26624
  s_waitcnt lgkmcnt(4)
  v_mfma_f32_32x32x16_bf16 v[96:111], v[160:163], v[212:215], v[96:111]
  ds_read_b128 v[152:155], v10 offset:60416
  s_waitcnt lgkmcnt(4)
  v_mfma_f32_32x32x16_bf16 v[112:127], v[164:167], v[212:215], v[112:127]
  ds_read_b128 v[156:159], v10 offset:27648
  s_waitcnt vmcnt(7) lgkmcnt(4)
  v_mfma_f32_32x32x16_bf16 v[80:95], v[168:171], v[216:219], v[80:95]
  ds_read_b128 v[160:163], v10 offset:28672
  v_permlane16_swap_b32 v208, v212
  v_permlane16_swap_b32 v209, v213
  s_waitcnt lgkmcnt(4)
  v_mfma_f32_32x32x16_bf16 v[96:111], v[144:147], v[216:219], v[96:111]
  ds_read_b128 v[164:167], v10 offset:29696
  v_permlane16_swap_b32 v210, v214
  v_permlane16_swap_b32_e64 v211, v215
  s_waitcnt lgkmcnt(4)
  v_mfma_f32_32x32x16_bf16 v[112:127], v[148:151], v[216:219], v[112:127]
  ds_read_b64 v[168:169], v16 offset:1024
  s_waitcnt lgkmcnt(4)
  v_mfma_f32_16x16x32_bf16 v[128:131], v[152:155], v[208:211], v[128:131]
  v_mfma_f32_16x16x32_bf16 v[132:135], v[152:155], v[212:215], v[132:135]
  ds_read_b64 v[144:145], v16 offset:1280
  s_waitcnt vmcnt(6) lgkmcnt(4)
  v_mfma_f32_32x32x16_bf16 v[80:95], v[156:159], v[220:223], v[80:95]
  ds_read_b64 v[148:149], v16 offset:1536
  s_waitcnt lgkmcnt(4)
  v_mfma_f32_32x32x16_bf16 v[96:111], v[160:163], v[220:223], v[96:111]
  ds_read_b64 v[152:153], v17 offset:1792
  s_waitcnt lgkmcnt(4)
  v_mfma_f32_32x32x16_bf16 v[112:127], v[164:167], v[220:223], v[112:127]
  ds_read_b128 v[156:159], v10 offset:30720
  s_waitcnt lgkmcnt(4)
  v_mfma_f32_32x32x16_bf16 v[80:95], v[168:171], v[252:255], v[80:95]
  ds_read_b128 v[160:163], v10 offset:31744
  s_waitcnt lgkmcnt(4)
  v_mfma_f32_32x32x16_bf16 v[96:111], v[144:147], v[252:255], v[96:111]
  ds_read_b128 v[164:167], v10 offset:32768
  s_waitcnt lgkmcnt(4)
  v_mfma_f32_32x32x16_bf16 v[112:127], v[148:151], v[252:255], v[112:127]
  ds_read_b128 v[168:171], v10 offset:61440
  s_waitcnt lgkmcnt(4)
  v_mfma_f32_16x16x32_bf16 v[128:131], v[152:155], v[240:243], v[128:131]
  v_mfma_f32_16x16x32_bf16 v[132:135], v[152:155], v[244:247], v[132:135]
  ds_read_b128 v[144:147], v10 offset:33792
  s_waitcnt vmcnt(5) lgkmcnt(4)
  v_mfma_f32_32x32x16_bf16 v[80:95], v[156:159], v[172:175], v[80:95]
  ds_read_b128 v[148:151], v10 offset:34816
  v_permlane16_swap_b32 v216, v220
  v_permlane16_swap_b32 v217, v221
  s_waitcnt lgkmcnt(4)
  v_mfma_f32_32x32x16_bf16 v[96:111], v[160:163], v[172:175], v[96:111]
  ds_read_b128 v[152:155], v10 offset:35840
  v_permlane16_swap_b32 v218, v222
  v_permlane16_swap_b32_e64 v219, v223
  s_waitcnt lgkmcnt(4)
  v_mfma_f32_32x32x16_bf16 v[112:127], v[164:167], v[172:175], v[112:127]
  ds_read_b128 v[156:159], v10 offset:36864
  s_waitcnt lgkmcnt(4)
  v_mfma_f32_16x16x32_bf16 v[128:131], v[168:171], v[216:219], v[128:131]
  v_mfma_f32_16x16x32_bf16 v[132:135], v[168:171], v[220:223], v[132:135]
  ds_read_b128 v[160:163], v10 offset:39936
  s_waitcnt vmcnt(4) lgkmcnt(4)
  v_mfma_f32_32x32x16_bf16 v[80:95], v[144:147], v[176:179], v[80:95]
  ds_read_b128 v[164:167], v10 offset:43008
  s_waitcnt lgkmcnt(4)
  v_mfma_f32_32x32x16_bf16 v[96:111], v[148:151], v[176:179], v[96:111]
  ds_read_b128 v[168:171], v10 offset:62464
  s_waitcnt lgkmcnt(4)
  v_mfma_f32_32x32x16_bf16 v[112:127], v[152:155], v[176:179], v[112:127]
  ds_read_b128 v[144:147], v10 offset:46080
  s_waitcnt vmcnt(3) lgkmcnt(4)
  v_mfma_f32_32x32x16_bf16 v[80:95], v[156:159], v[180:183], v[80:95]
  ds_read_b128 v[148:151], v10 offset:37888
  v_permlane16_swap_b32 v172, v176
  v_permlane16_swap_b32 v173, v177
  s_waitcnt vmcnt(2) lgkmcnt(4)
  v_mfma_f32_32x32x16_bf16 v[80:95], v[160:163], v[184:187], v[80:95]
  ds_read_b128 v[152:155], v10 offset:40960
  v_permlane16_swap_b32 v174, v178
  v_permlane16_swap_b32_e64 v175, v179
  s_waitcnt vmcnt(1) lgkmcnt(4)
  v_mfma_f32_32x32x16_bf16 v[80:95], v[164:167], v[188:191], v[80:95]
  ds_read_b128 v[156:159], v10 offset:44032
  s_waitcnt lgkmcnt(4)
  v_mfma_f32_16x16x32_bf16 v[128:131], v[168:171], v[172:175], v[128:131]
  v_mfma_f32_16x16x32_bf16 v[132:135], v[168:171], v[176:179], v[132:135]
  ds_read_b128 v[160:163], v10 offset:47104
  s_waitcnt vmcnt(0) lgkmcnt(4)
  v_mfma_f32_32x32x16_bf16 v[80:95], v[144:147], v[192:195], v[80:95]
  ds_read_b128 v[164:167], v10 offset:38912
  s_waitcnt lgkmcnt(4)
  v_mfma_f32_32x32x16_bf16 v[96:111], v[148:151], v[180:183], v[96:111]
  ds_read_b128 v[168:171], v10 offset:41984
  s_waitcnt lgkmcnt(4)
  v_mfma_f32_32x32x16_bf16 v[96:111], v[152:155], v[184:187], v[96:111]
  ds_read_b128 v[144:147], v10 offset:45056
  s_nop 4
  s_nop 0
  v_cvt_pk_bf16_f32 v224, v80, v81
  v_cvt_pk_bf16_f32 v225, v82, v83
  v_cvt_pk_bf16_f32 v226, v84, v85
  v_cvt_pk_bf16_f32 v227, v86, v87
  v_pk_max_i16 v224, v224, 0
  v_pk_max_i16 v225, v225, 0
  s_waitcnt lgkmcnt(4)
  v_mfma_f32_32x32x16_bf16 v[96:111], v[156:159], v[188:191], v[96:111]
  s_nop 0
  ds_read_b128 v[148:151], v10 offset:63488
  v_pk_max_i16 v226, v226, 0
  v_pk_max_i16 v227, v227, 0
  buffer_store_dwordx4 v[224:227], v1, s[16:19], s74 offen offset:0
  v_cvt_pk_bf16_f32 v228, v88, v89
  v_cvt_pk_bf16_f32 v229, v90, v91
  v_cvt_pk_bf16_f32 v230, v92, v93
  s_waitcnt lgkmcnt(4)
  v_mfma_f32_32x32x16_bf16 v[96:111], v[160:163], v[192:195], v[96:111]
  s_nop 0
  ds_read_b128 v[152:155], v10 offset:48128
  v_cvt_pk_bf16_f32 v231, v94, v95
  v_pk_max_i16 v228, v228, 0
  v_pk_max_i16 v229, v229, 0
  v_pk_max_i16 v230, v230, 0
  v_pk_max_i16 v231, v231, 0
  buffer_store_dwordx4 v[228:231], v1, s[16:19], s74 offen offset:1024
  s_waitcnt lgkmcnt(4)
  v_mfma_f32_32x32x16_bf16 v[112:127], v[164:167], v[180:183], v[112:127]
  ds_read_b128 v[156:159], v10 offset:64512
  s_waitcnt lgkmcnt(4)
  v_mfma_f32_32x32x16_bf16 v[112:127], v[168:171], v[184:187], v[112:127]
  v_cvt_pk_bf16_f32 v232, v96, v97
  v_cvt_pk_bf16_f32 v233, v98, v99
  v_cvt_pk_bf16_f32 v234, v100, v101
  v_cvt_pk_bf16_f32 v235, v102, v103
  v_pk_max_i16 v232, v232, 0
  v_pk_max_i16 v233, v233, 0
  v_permlane16_swap_b32 v180, v184
  v_permlane16_swap_b32 v181, v185
  v_permlane16_swap_b32 v182, v186
  v_permlane16_swap_b32_e64 v183, v187
  s_waitcnt lgkmcnt(3)
  v_mfma_f32_32x32x16_bf16 v[112:127], v[144:147], v[188:191], v[112:127]
  v_pk_max_i16 v234, v234, 0
  v_pk_max_i16 v235, v235, 0
  buffer_store_dwordx4 v[232:235], v1, s[16:19], s74 offen offset:2048 sc1
  v_cvt_pk_bf16_f32 v236, v104, v105
  v_cvt_pk_bf16_f32 v237, v106, v107
  v_cvt_pk_bf16_f32 v238, v108, v109
  s_waitcnt lgkmcnt(2)
  v_mfma_f32_16x16x32_bf16 v[128:131], v[148:151], v[180:183], v[128:131]
  v_mfma_f32_16x16x32_bf16 v[132:135], v[148:151], v[184:187], v[132:135]
  s_waitcnt lgkmcnt(1)
  v_mfma_f32_32x32x16_bf16 v[112:127], v[152:155], v[192:195], v[112:127]
  v_cvt_pk_bf16_f32 v239, v110, v111
  v_pk_max_i16 v236, v236, 0
  v_pk_max_i16 v237, v237, 0
  v_pk_max_i16 v238, v238, 0
  v_pk_max_i16 v239, v239, 0
  buffer_store_dwordx4 v[236:239], v1, s[16:19], s74 offen offset:3072 sc1
  v_permlane16_swap_b32 v188, v192
  v_permlane16_swap_b32 v189, v193
  v_permlane16_swap_b32 v190, v194
  v_permlane16_swap_b32 v191, v195
  s_waitcnt lgkmcnt(0)
  s_nop 0
  v_mfma_f32_16x16x32_bf16 v[128:131], v[156:159], v[188:191], v[128:131]
  v_mfma_f32_16x16x32_bf16 v[132:135], v[156:159], v[192:195], v[132:135]
  v_cvt_pk_bf16_f32 v224, v112, v113
  v_cvt_pk_bf16_f32 v225, v114, v115
  v_cvt_pk_bf16_f32 v226, v116, v117
  v_cvt_pk_bf16_f32 v227, v118, v119
  v_pk_max_i16 v224, v224, 0
  v_pk_max_i16 v225, v225, 0
  v_pk_max_i16 v226, v226, 0
  v_pk_max_i16 v227, v227, 0
  buffer_store_dwordx4 v[224:227], v1, s[16:19], s75 offen offset:0 sc1
  v_cvt_pk_bf16_f32 v228, v120, v121
  v_cvt_pk_bf16_f32 v229, v122, v123
  v_cvt_pk_bf16_f32 v230, v124, v125
  v_cvt_pk_bf16_f32 v231, v126, v127
  v_pk_max_i16 v228, v228, 0
  v_pk_max_i16 v229, v229, 0
  v_pk_max_i16 v230, v230, 0
  v_pk_max_i16 v231, v231, 0
  buffer_store_dwordx4 v[228:231], v1, s[16:19], s75 offen offset:1024 sc1
  v_cvt_pk_bf16_f32 v240, v128, v129
  v_cvt_pk_bf16_f32 v241, v130, v131
  v_pk_max_i16 v240, v240, 0
  v_pk_max_i16 v241, v241, 0
  buffer_store_dwordx2 v[240:241], v11, s[16:19], s75 offen offset:2048 sc1
  v_cvt_pk_bf16_f32 v242, v132, v133
  v_cvt_pk_bf16_f32 v243, v134, v135
  v_pk_max_i16 v242, v242, 0
  v_pk_max_i16 v243, v243, 0
  buffer_store_dwordx2 v[242:243], v11, s[16:19], s75 offen offset:2304 sc1
  v_mov_b32_e64 v30, 9
  s_mov_b64 exec, 1
  s_cmp_lg_u32 s40, 0
  s_waitcnt vmcnt(0)
  s_cbranch_scc1 L59
  buffer_store_dword v30, off, s[16:19], s42
  s_branch L60
L59:
  buffer_wbl2 sc1
  s_waitcnt vmcnt(0)
  buffer_store_dword v30, off, s[16:19], s42 sc1
L60:
  s_mov_b64 exec, -1
  s_lshl_b32 s78, s38, 2
  s_add_u32 s78, s78, s32
  s_mul_i32 s78, s78, 14336
  s_add_u32 s78, s78, 8388608
  s_xor_b32 s72, s46, 3
  s_mul_i32 s72, s72, 114688
  s_add_u32 s72, s72, s78
  s_xor_b32 s73, s46, 2
  s_mul_i32 s73, s73, 114688
  s_add_u32 s73, s73, s78
  s_xor_b32 s74, s46, 1
  s_mul_i32 s74, s74, 114688
  s_add_u32 s74, s74, s78
  s_xor_b32 s75, s46, 0
  s_mul_i32 s75, s75, 114688
  s_add_u32 s75, s75, s78
  s_add_u32 s80, s61, 0
  s_add_u32 s81, s62, 1572864
  s_add_u32 s76, s60, 0
  s_xor_b32 s77, s76, 0x10000
  s_sub_u32 s79, s42, s41
  s_xor_b32 s79, s79, 16
  v_mov_b32 v254, s79
  s_lshl_b32 s79, s35, 8
  v_add_u32 v253, s79, v28
  v_mov_b32 v252, 0x3f803f80
  v_and_b32 v31, 1, v0
  v_lshlrev_b32 v31, 4, v31
  s_mov_b32 s79, 0x3f80
  v_lshlrev_b32 v31, v31, s79
  buffer_load_dword v30, v253, s[16:19], s41 offen sc1
  s_mov_b32 s82, 0x3
  s_mov_b32 s83, 0x30
  v_cndmask_b32 v240, 0, v31, s[82:83]
  s_mov_b32 s82, 0xc
  s_nop 0
  s_mov_b32 s83, 0xc0
  v_cndmask_b32 v241, 0, v31, s[82:83]
  s_mov_b32 s82, 0x300
  s_mov_b32 s83, 0x3000
  v_cndmask_b32 v242, 0, v31, s[82:83]
  s_mov_b32 s82, 0xc00
  s_mov_b32 s83, 0xc000
  v_cndmask_b32 v243, 0, v31, s[82:83]
  s_mov_b32 s82, 0x30000
  s_mov_b32 s83, 0x300000
  v_cndmask_b32 v248, 0, v31, s[82:83]
  s_mov_b32 s82, 0xc0000
  s_mov_b32 s83, 0xc00000
  v_cndmask_b32 v249, 0, v31, s[82:83]
  s_mov_b32 s82, 0x3000000
  s_mov_b32 s83, 0x30000000
  v_cndmask_b32 v250, 0, v31, s[82:83]
  s_mov_b32 s82, 0xc000000
  s_mov_b32 s83, 0xc0000000
  v_cndmask_b32 v251, 0, v31, s[82:83]
  s_mov_b32 s44, 0
L61:
  buffer_load_dword v7, v253, s[16:19], s41 offen sc1
  s_waitcnt vmcnt(1)
  v_cmp_gt_i32_e64 vcc, 9, v30
  s_cbranch_vccz L62
  buffer_load_dword v30, v253, s[16:19], s41 offen sc1
  s_add_u32 s44, s44, 1
  s_cmp_gt_u32 s44, 200000
  s_cbranch_scc1 Lend
  s_waitcnt vmcnt(1)
  v_cmp_gt_i32_e64 vcc, 9, v7
  s_cbranch_vccnz L61
L62:
  s_cmp_eq_u32 s40, 0
  s_cbranch_scc1 L63
  buffer_inv sc1
  s_waitcnt vmcnt(0)
L63:
  s_nop 0
  buffer_load_dwordx4 v[176:179], v1, s[16:19], s72 offen offset:0 sc1
  buffer_load_dwordx4 v[180:183], v1, s[16:19], s72 offen offset:1024 sc1
  buffer_load_dwordx4 v[184:187], v1, s[16:19], s72 offen offset:2048 sc1
  buffer_load_dwordx4 v[188:191], v1, s[16:19], s72 offen offset:3072 sc1
  s_add_u32 s72, s72, 4096
  buffer_load_dwordx4 v[192:195], v1, s[16:19], s72 offen offset:0 sc1
  buffer_load_dwordx4 v[196:199], v1, s[16:19], s72 offen offset:1024 sc1
  s_waitcnt vmcnt(5)
  v_mfma_f32_32x32x16_bf16 v[96:111], a[4:7], v[176:179], 0
  buffer_load_dwordx4 v[200:203], v1, s[16:19], s72 offen offset:2048 sc1
  v_mfma_f32_32x32x16_bf16 v[80:95], a[0:3], v[176:179], 0
  buffer_load_dwordx4 v[204:207], v1, s[16:19], s72 offen offset:3072 sc1
  s_waitcnt vmcnt(6)
  v_mfma_f32_32x32x16_bf16 v[96:111], a[12:15], v[180:183], v[96:111]
  s_add_u32 s72, s72, 4096
  buffer_load_dwordx4 v[208:211], v1, s[16:19], s72 offen offset:0 sc1
  v_mfma_f32_32x32x16_bf16 v[80:95], a[8:11], v[180:183], v[80:95]
  buffer_load_dwordx4 v[212:215], v1, s[16:19], s72 offen offset:1024 sc1
  s_waitcnt vmcnt(7)
  v_mfma_f32_32x32x16_bf16 v[96:111], a[20:23], v[184:187], v[96:111]
  buffer_load_dwordx4 v[216:219], v1, s[16:19], s72 offen offset:2048 sc1
  v_mfma_f32_32x32x16_bf16 v[80:95], a[16:19], v[184:187], v[80:95]
  buffer_load_dwordx4 v[220:223], v1, s[16:19], s72 offen offset:3072 sc1
  s_waitcnt vmcnt(8)
  v_mfma_f32_32x32x16_bf16 v[96:111], a[28:31], v[188:191], v[96:111]
  s_add_u32 s72, s72, 4096
  buffer_load_dwordx4 v[224:227], v1, s[16:19], s72 offen offset:0 sc1
  v_mfma_f32_32x32x16_bf16 v[80:95], a[24:27], v[188:191], v[80:95]
  s_waitcnt vmcnt(8)
  v_mfma_f32_32x32x16_bf16 v[96:111], a[36:39], v[192:195], v[96:111]
  buffer_load_dwordx4 v[228:231], v1, s[16:19], s72 offen offset:1024 sc1
  v_mfma_f32_32x32x16_bf16 v[80:95], a[32:35], v[192:195], v[80:95]
  s_waitcnt vmcnt(8)
  v_mfma_f32_32x32x16_bf16 v[96:111], a[44:47], v[196:199], v[96:111]
  buffer_load_dwordx4 v[232:235], v1, s[16:19], s73 offen offset:0 sc1
  v_mfma_f32_32x32x16_bf16 v[80:95], a[40:43], v[196:199], v[80:95]
  s_waitcnt vmcnt(8)
  v_mfma_f32_32x32x16_bf16 v[96:111], a[52:55], v[200:203], v[96:111]
  buffer_load_dwordx4 v[236:239], v1, s[16:19], s73 offen offset:1024 sc1
  v_mfma_f32_32x32x16_bf16 v[80:95], a[48:51], v[200:203], v[80:95]
  s_waitcnt vmcnt(8)
  v_mfma_f32_32x32x16_bf16 v[96:111], a[60:63], v[204:207], v[96:111]
  buffer_load_dwordx4 v[176:179], v1, s[16:19], s73 offen offset:2048 sc1
  v_mfma_f32_32x32x16_bf16 v[80:95], a[56:59], v[204:207], v[80:95]
  s_waitcnt vmcnt(8)
  v_mfma_f32_32x32x16_bf16 v[96:111], a[68:71], v[208:211], v[96:111]
  buffer_load_dwordx4 v[180:183], v1, s[16:19], s73 offen offset:3072 sc1
  v_mfma_f32_32x32x16_bf16 v[80:95], a[64:67], v[208:211], v[80:95]
  s_waitcnt vmcnt(8)
  v_mfma_f32_32x32x16_bf16 v[96:111], a[76:79], v[212:215], v[96:111]
  s_add_u32 s73, s73, 4096
  buffer_load_dwordx4 v[184:187], v1, s[16:19], s73 offen offset:0 sc1
  v_mfma_f32_32x32x16_bf16 v[80:95], a[72:75], v[212:215], v[80:95]
  s_waitcnt vmcnt(8)
  v_mfma_f32_32x32x16_bf16 v[96:111], a[84:87], v[216:219], v[96:111]
  buffer_load_dwordx4 v[188:191], v1, s[16:19], s73 offen offset:1024 sc1
  v_mfma_f32_32x32x16_bf16 v[80:95], a[80:83], v[216:219], v[80:95]
  s_waitcnt vmcnt(8)
  v_mfma_f32_32x32x16_bf16 v[96:111], a[92:95], v[220:223], v[96:111]
  buffer_load_dwordx4 v[192:195], v1, s[16:19], s73 offen offset:2048 sc1
  v_mfma_f32_32x32x16_bf16 v[80:95], a[88:91], v[220:223], v[80:95]
  s_waitcnt vmcnt(8)
  v_mfma_f32_32x32x16_bf16 v[96:111], a[100:103], v[224:227], v[96:111]
  buffer_load_dwordx4 v[196:199], v1, s[16:19], s73 offen offset:3072 sc1
  v_mfma_f32_32x32x16_bf16 v[80:95], a[96:99], v[224:227], v[80:95]
  s_waitcnt vmcnt(8)
  v_mfma_f32_32x32x16_bf16 v[96:111], a[108:111], v[228:231], v[96:111]
  s_add_u32 s73, s73, 4096
  buffer_load_dwordx4 v[200:203], v1, s[16:19], s73 offen offset:0 sc1
  v_mfma_f32_32x32x16_bf16 v[80:95], a[104:107], v[228:231], v[80:95]
  s_waitcnt vmcnt(8)
  v_mfma_f32_32x32x16_bf16 v[128:143], a[4:7], v[232:235], 0
  buffer_load_dwordx4 v[204:207], v1, s[16:19], s73 offen offset:1024 sc1
  v_mfma_f32_32x32x16_bf16 v[112:127], a[0:3], v[232:235], 0
  s_waitcnt vmcnt(8)
  v_mfma_f32_32x32x16_bf16 v[128:143], a[12:15], v[236:239], v[128:143]
  buffer_load_dwordx4 v[208:211], v1, s[16:19], s73 offen offset:2048 sc1
  s_nop 1
  ds_write_b128 v2, v[96:99] offset:4096
  v_mfma_f32_32x32x16_bf16 v[112:127], a[8:11], v[236:239], v[112:127]
  ds_write_b128 v2, v[100:103] offset:5120
  s_waitcnt vmcnt(8)
  v_mfma_f32_32x32x16_bf16 v[128:143], a[20:23], v[176:179], v[128:143]
  buffer_load_dwordx4 v[212:215], v1, s[16:19], s73 offen offset:3072 sc1
  v_mfma_f32_32x32x16_bf16 v[112:127], a[16:19], v[176:179], v[112:127]
  ds_write_b128 v2, v[104:107] offset:6144
  s_waitcnt vmcnt(8)
  v_mfma_f32_32x32x16_bf16 v[128:143], a[28:31], v[180:183], v[128:143]
  s_add_u32 s73, s73, 4096
  buffer_load_dwordx4 v[216:219], v1, s[16:19], s73 offen offset:0 sc1
  ds_write_b128 v2, v[108:111] offset:7168
  v_mfma_f32_32x32x16_bf16 v[112:127], a[24:27], v[180:183], v[112:127]
  s_waitcnt vmcnt(8)
  v_mfma_f32_32x32x16_bf16 v[128:143], a[36:39], v[184:187], v[128:143]
  buffer_load_dwordx4 v[220:223], v1, s[16:19], s73 offen offset:1024 sc1
  ds_write_b128 v19, v[80:83] offset:0
  v_mfma_f32_32x32x16_bf16 v[112:127], a[32:35], v[184:187], v[112:127]
  ds_write_b128 v19, v[84:87] offset:1024
  s_waitcnt vmcnt(8)
  v_mfma_f32_32x32x16_bf16 v[128:143], a[44:47], v[188:191], v[128:143]
  buffer_load_dwordx4 v[224:227], v1, s[16:19], s74 offen offset:0 sc1
  v_mfma_f32_32x32x16_bf16 v[112:127], a[40:43], v[188:191], v[112:127]
  ds_write_b128 v19, v[88:91] offset:2048
  s_waitcnt vmcnt(8)
  v_mfma_f32_32x32x16_bf16 v[128:143], a[52:55], v[192:195], v[128:143]
  buffer_load_dwordx4 v[228:231], v1, s[16:19], s74 offen offset:1024 sc1
  ds_write_b128 v19, v[92:95] offset:3072
  v_mfma_f32_32x32x16_bf16 v[112:127], a[48:51], v[192:195], v[112:127]
  s_waitcnt lgkmcnt(0)
  s_barrier
  ds_read_b128 v[144:147], v18 offset:0
  ds_read_b128 v[148:151], v18 offset:1024
  s_waitcnt vmcnt(8)
  v_mfma_f32_32x32x16_bf16 v[128:143], a[60:63], v[196:199], v[128:143]
  buffer_load_dwordx4 v[232:235], v1, s[16:19], s74 offen offset:2048 sc1
  ds_read_b128 v[152:155], v18 offset:2048
  ds_read_b128 v[156:159], v18 offset:3072
  ds_read_b128 v[160:163], v18 offset:4096
  v_mfma_f32_32x32x16_bf16 v[112:127], a[56:59], v[196:199], v[112:127]
  ds_read_b128 v[164:167], v18 offset:5120
  ds_read_b128 v[168:171], v18 offset:6144
  ds_read_b128 v[172:175], v18 offset:7168
  s_waitcnt vmcnt(8)
  v_mfma_f32_32x32x16_bf16 v[128:143], a[68:71], v[200:203], v[128:143]
  buffer_load_dwordx4 v[236:239], v1, s[16:19], s74 offen offset:3072 sc1
  v_mfma_f32_32x32x16_bf16 v[112:127], a[64:67], v[200:203], v[112:127]
  s_waitcnt lgkmcnt(0)
  v_add_f32 v144, v144, v160
  v_add_f32 v145, v145, v161
  v_add_f32_e64 v146, v146, v162
  s_waitcnt vmcnt(8)
  v_mfma_f32_32x32x16_bf16 v[128:143], a[76:79], v[204:207], v[128:143]
  s_add_u32 s74, s74, 4096
  buffer_load_dwordx4 v[176:179], v1, s[16:19], s74 offen offset:0 sc1
  v_add_f32 v147, v147, v163
  v_add_f32 v148, v148, v164
  v_add_f32_e64 v149, v149, v165
  v_mfma_f32_32x32x16_bf16 v[112:127], a[72:75], v[204:207], v[112:127]
  v_add_f32 v150, v150, v166
  v_add_f32 v151, v151, v167
  v_add_f32 v152, v152, v168
  v_add_f32_e64 v153, v153, v169
  s_waitcnt vmcnt(8)
  v_mfma_f32_32x32x16_bf16 v[128:143], a[84:87], v[208:211], v[128:143]
  buffer_load_dwordx4 v[180:183], v1, s[16:19], s74 offen offset:1024 sc1
  v_add_f32 v154, v154, v170
  v_add_f32 v155, v155, v171
  v_add_f32_e64 v156, v156, v172
  v_mfma_f32_32x32x16_bf16 v[112:127], a[80:83], v[208:211], v[112:127]
  v_add_f32 v157, v157, v173
  v_add_f32 v158, v158, v174
  v_add_f32 v159, v159, v175
  s_waitcnt vmcnt(8)
  v_mfma_f32_32x32x16_bf16 v[128:143], a[92:95], v[212:215], v[128:143]
  buffer_load_dwordx4 v[184:187], v1, s[16:19], s74 offen offset:2048 sc1
  v_mfma_f32_32x32x16_bf16 v[112:127], a[88:91], v[212:215], v[112:127]
  s_waitcnt vmcnt(8)
  v_mfma_f32_32x32x16_bf16 v[128:143], a[100:103], v[216:219], v[128:143]
  buffer_load_dwordx4 v[188:191], v1, s[16:19], s74 offen offset:3072 sc1
  v_mfma_f32_32x32x16_bf16 v[112:127], a[96:99], v[216:219], v[112:127]
  s_waitcnt vmcnt(8)
  v_mfma_f32_32x32x16_bf16 v[128:143], a[108:111], v[220:223], v[128:143]
  s_add_u32 s74, s74, 4096
  buffer_load_dwordx4 v[192:195], v1, s[16:19], s74 offen offset:0 sc1
  v_mfma_f32_32x32x16_bf16 v[112:127], a[104:107], v[220:223], v[112:127]
  s_waitcnt vmcnt(8)
  v_mfma_f32_32x32x16_bf16 v[96:111], a[4:7], v[224:227], 0
  buffer_load_dwordx4 v[196:199], v1, s[16:19], s74 offen offset:1024 sc1
  v_mfma_f32_32x32x16_bf16 v[80:95], a[0:3], v[224:227], 0
  s_waitcnt vmcnt(8)
  v_mfma_f32_32x32x16_bf16 v[96:111], a[12:15], v[228:231], v[96:111]
  buffer_load_dwordx4 v[200:203], v1, s[16:19], s74 offen offset:2048 sc1
  s_nop 1
  ds_write_b128 v18, v[128:131] offset:0
  v_mfma_f32_32x32x16_bf16 v[80:95], a[8:11], v[228:231], v[80:95]
  ds_write_b128 v18, v[132:135] offset:1024
  s_waitcnt vmcnt(8)
  v_mfma_f32_32x32x16_bf16 v[96:111], a[20:23], v[232:235], v[96:111]
  buffer_load_dwordx4 v[204:207], v1, s[16:19], s74 offen offset:3072 sc1
  v_mfma_f32_32x32x16_bf16 v[80:95], a[16:19], v[232:235], v[80:95]
  ds_write_b128 v18, v[136:139] offset:2048
  s_waitcnt vmcnt(8)
  v_mfma_f32_32x32x16_bf16 v[96:111], a[28:31], v[236:239], v[96:111]
  s_add_u32 s74, s74, 4096
  buffer_load_dwordx4 v[208:211], v1, s[16:19], s74 offen offset:0 sc1
  ds_write_b128 v18, v[140:143] offset:3072
  v_mfma_f32_32x32x16_bf16 v[80:95], a[24:27], v[236:239], v[80:95]
  s_waitcnt lgkmcnt(0)
  s_barrier
  ds_read_b128 v[160:163], v20 offset:0
  ds_read_b128 v[164:167], v20 offset:1024
  s_waitcnt vmcnt(8)
  v_mfma_f32_32x32x16_bf16 v[96:111], a[36:39], v[176:179], v[96:111]
  buffer_load_dwordx4 v[212:215], v1, s[16:19], s74 offen offset:1024 sc1
  ds_read_b128 v[168:171], v20 offset:2048
  ds_read_b128 v[172:175], v20 offset:3072
  v_add_f32_e64 v144, v144, v112
  v_mfma_f32_32x32x16_bf16 v[80:95], a[32:35], v[176:179], v[80:95]
  v_add_f32 v145, v145, v113
  v_add_f32 v146, v146, v114
  v_add_f32 v147, v147, v115
  v_add_f32_e64 v148, v148, v116
  s_waitcnt vmcnt(8)
  v_mfma_f32_32x32x16_bf16 v[96:111], a[44:47], v[180:183], v[96:111]
  buffer_load_dwordx4 v[216:219], v1, s[16:19], s75 offen offset:0 sc1
  v_add_f32 v149, v149, v117
  v_add_f32 v150, v150, v118
  v_add_f32_e64 v151, v151, v119
  v_mfma_f32_32x32x16_bf16 v[80:95], a[40:43], v[180:183], v[80:95]
  v_add_f32 v152, v152, v120
  v_add_f32 v153, v153, v121
  v_add_f32 v154, v154, v122
  v_add_f32_e64 v155, v155, v123
  s_waitcnt vmcnt(8)
  v_mfma_f32_32x32x16_bf16 v[96:111], a[52:55], v[184:187], v[96:111]
  buffer_load_dwordx4 v[220:223], v1, s[16:19], s75 offen offset:1024 sc1
  v_add_f32 v156, v156, v124
  v_add_f32 v157, v157, v125
  v_add_f32_e64 v158, v158, v126
  v_mfma_f32_32x32x16_bf16 v[80:95], a[48:51], v[184:187], v[80:95]
  v_add_f32 v159, v159, v127
  s_waitcnt lgkmcnt(0)
  v_add_f32 v144, v144, v160
  v_add_f32_e64 v145, v145, v161
  s_waitcnt vmcnt(8)
  v_mfma_f32_32x32x16_bf16 v[96:111], a[60:63], v[188:191], v[96:111]
  buffer_load_dwordx4 v[224:227], v1, s[16:19], s75 offen offset:2048 sc1
  v_add_f32 v146, v146, v162
  v_add_f32 v147, v147, v163
  v_add_f32_e64 v148, v148, v164
  v_mfma_f32_32x32x16_bf16 v[80:95], a[56:59], v[188:191], v[80:95]
  v_add_f32 v149, v149, v165
  v_add_f32 v150, v150, v166
  v_add_f32 v151, v151, v167
  v_add_f32_e64 v152, v152, v168
  s_waitcnt vmcnt(8)
  v_mfma_f32_32x32x16_bf16 v[96:111], a[68:71], v[192:195], v[96:111]
  buffer_load_dwordx4 v[228:231], v1, s[16:19], s75 offen offset:3072 sc1
  v_add_f32 v153, v153, v169
  v_add_f32 v154, v154, v170
  v_add_f32_e64 v155, v155, v171
  v_mfma_f32_32x32x16_bf16 v[80:95], a[64:67], v[192:195], v[80:95]
  v_add_f32 v156, v156, v172
  v_add_f32 v157, v157, v173
  v_add_f32 v158, v158, v174
  v_add_f32_e64 v159, v159, v175
  s_waitcnt vmcnt(8)
  v_mfma_f32_32x32x16_bf16 v[96:111], a[76:79], v[196:199], v[96:111]
  s_add_u32 s75, s75, 4096
  buffer_load_dwordx4 v[232:235], v1, s[16:19], s75 offen offset:0 sc1
  v_cvt_pk_bf16_f32 v160, v144, v145
  v_cvt_pk_bf16_f32 v161, v146, v147
  v_cvt_pk_bf16_f32 v162, v148, v149
  v_mfma_f32_32x32x16_bf16 v[80:95], a[72:75], v[196:199], v[80:95]
  v_cvt_pk_bf16_f32 v163, v150, v151
  v_cvt_pk_bf16_f32 v164, v152, v153
  v_cvt_pk_bf16_f32 v165, v154, v155
  v_cvt_pk_bf16_f32 v166, v156, v157
  s_waitcnt vmcnt(8)
  v_mfma_f32_32x32x16_bf16 v[96:111], a[84:87], v[200:203], v[96:111]
  buffer_load_dwordx4 v[236:239], v1, s[16:19], s75 offen offset:1024 sc1
  v_cvt_pk_bf16_f32 v167, v158, v159
  buffer_store_dwordx4 v[160:163], v15, s[12:15], s77 offen offset:0
  buffer_store_dwordx4 v[164:167], v15, s[12:15], s77 offen offset:32
  v_mfma_f32_32x32x16_bf16 v[80:95], a[80:83], v[200:203], v[80:95]
  s_waitcnt vmcnt(10)
  v_mfma_f32_32x32x16_bf16 v[96:111], a[92:95], v[204:207], v[96:111]
  buffer_load_dwordx4 v[176:179], v1, s[16:19], s75 offen offset:2048 sc1
  v_mfma_f32_32x32x16_bf16 v[80:95], a[88:91], v[204:207], v[80:95]
  s_waitcnt vmcnt(10)
  v_mfma_f32_32x32x16_bf16 v[96:111], a[100:103], v[208:211], v[96:111]
  buffer_load_dwordx4 v[180:183], v1, s[16:19], s75 offen offset:3072 sc1
  v_mfma_f32_32x32x16_bf16 v[80:95], a[96:99], v[208:211], v[80:95]
  s_waitcnt vmcnt(10)
  v_mfma_f32_32x32x16_bf16 v[96:111], a[108:111], v[212:215], v[96:111]
  s_add_u32 s75, s75, 4096
  buffer_load_dwordx4 v[184:187], v1, s[16:19], s75 offen offset:0 sc1
  v_mfma_f32_32x32x16_bf16 v[80:95], a[104:107], v[212:215], v[80:95]
  s_waitcnt vmcnt(10)
  v_mfma_f32_32x32x16_bf16 v[128:143], a[4:7], v[216:219], 0
  buffer_load_dwordx4 v[188:191], v1, s[16:19], s75 offen offset:1024 sc1
  v_mfma_f32_32x32x16_bf16 v[112:127], a[0:3], v[216:219], 0
  s_waitcnt vmcnt(10)
  v_mfma_f32_32x32x16_bf16 v[128:143], a[12:15], v[220:223], v[128:143]
  buffer_load_dwordx4 v[192:195], v1, s[16:19], s75 offen offset:2048 sc1
  s_nop 1
  ds_write_b128 v2, v[96:99] offset:4096
  v_mfma_f32_32x32x16_bf16 v[112:127], a[8:11], v[220:223], v[112:127]
  ds_write_b128 v2, v[100:103] offset:5120
  s_waitcnt vmcnt(10)
  v_mfma_f32_32x32x16_bf16 v[128:143], a[20:23], v[224:227], v[128:143]
  buffer_load_dwordx4 v[196:199], v1, s[16:19], s75 offen offset:3072 sc1
  v_mov_b32_e64 v30, 10
  s_mov_b64 exec, 1
  s_cmp_lg_u32 s40, 0
  s_waitcnt vmcnt(6)
  s_cbranch_scc1 L64
  buffer_store_dword v30, off, s[16:19], s42
  s_branch L65
L64:
  buffer_wbl2 sc1
  s_waitcnt vmcnt(0)
  buffer_store_dword v30, off, s[16:19], s42 sc1
L65:
  s_mov_b64 exec, -1
  v_mfma_f32_32x32x16_bf16 v[112:127], a[16:19], v[224:227], v[112:127]
  ds_write_b128 v2, v[104:107] offset:6144
  v_mfma_f32_32x32x16_bf16 v[128:143], a[28:31], v[228:231], v[128:143]
  s_add_u32 s75, s75, 4096
  buffer_load_dwordx4 v[200:203], v1, s[16:19], s75 offen offset:0 sc1
  ds_write_b128 v2, v[108:111] offset:7168
  s_barrier
  v_mfma_f32_32x32x16_bf16 v[112:127], a[24:27], v[228:231], v[112:127]
  v_mfma_f32_32x32x16_bf16 v[128:143], a[36:39], v[232:235], v[128:143]
  buffer_load_dwordx4 v[204:207], v1, s[16:19], s75 offen offset:1024 sc1
  ds_write_b128 v19, v[80:83] offset:0
  v_mfma_f32_32x32x16_bf16 v[112:127], a[32:35], v[232:235], v[112:127]
  ds_write_b128 v19, v[84:87] offset:1024
  v_mfma_f32_32x32x16_bf16 v[128:143], a[44:47], v[236:239], v[128:143]
  v_mfma_f32_32x32x16_bf16 v[112:127], a[40:43], v[236:239], v[112:127]
  ds_write_b128 v19, v[88:91] offset:2048
  s_waitcnt vmcnt(8)
  v_mfma_f32_32x32x16_bf16 v[128:143], a[52:55], v[176:179], v[128:143]
  ds_write_b128 v19, v[92:95] offset:3072
  v_mfma_f32_32x32x16_bf16 v[112:127], a[48:51], v[176:179], v[112:127]
  s_waitcnt lgkmcnt(0)
  s_barrier
  ds_read_b128 v[144:147], v18 offset:0
  ds_read_b128 v[148:151], v18 offset:1024
  s_waitcnt vmcnt(7)
  v_mfma_f32_32x32x16_bf16 v[128:143], a[60:63], v[180:183], v[128:143]
  ds_read_b128 v[152:155], v18 offset:2048
  ds_read_b128 v[156:159], v18 offset:3072
  ds_read_b128 v[160:163], v18 offset:4096
  ds_read_b128 v[164:167], v18 offset:5120
  v_mfma_f32_32x32x16_bf16 v[112:127], a[56:59], v[180:183], v[112:127]
  ds_read_b128 v[168:171], v18 offset:6144
  ds_read_b128 v[172:175], v18 offset:7168
  ds_read_b32 v246, v25 offset:2560
  s_waitcnt vmcnt(6)
  v_mfma_f32_32x32x16_bf16 v[128:143], a[68:71], v[184:187], v[128:143]
  buffer_load_dword v31, v254, s[16:19], s41 offen sc1
  v_mfma_f32_32x32x16_bf16 v[112:127], a[64:67], v[184:187], v[112:127]
  s_waitcnt lgkmcnt(0)
  v_fmac_f32 v32, v144, v246
  v_fmac_f32_e64 v33, v145, v246
  s_waitcnt vmcnt(6)
  v_mfma_f32_32x32x16_bf16 v[128:143], a[76:79], v[188:191], v[128:143]
  v_fmac_f32 v34, v146, v246
  v_fmac_f32 v35, v147, v246
  v_fmac_f32 v36, v148, v246
  v_fmac_f32_e64 v37, v149, v246
  s_waitcnt vmcnt(5)
  v_mfma_f32_32x32x16_bf16 v[128:143], a[84:87], v[192:195], v[128:143]
  v_fmac_f32 v38, v150, v246
  v_fmac_f32 v39, v151, v246
  v_fmac_f32 v40, v152, v246
  v_fmac_f32_e64 v41, v153, v246
  s_waitcnt vmcnt(4)
  v_mfma_f32_32x32x16_bf16 v[128:143], a[92:95], v[196:199], v[128:143]
  v_fmac_f32 v42, v154, v246
  v_fmac_f32 v43, v155, v246
  v_fmac_f32 v44, v156, v246
  v_fmac_f32_e64 v45, v157, v246
  s_waitcnt vmcnt(2)
  v_mfma_f32_32x32x16_bf16 v[128:143], a[100:103], v[200:203], v[128:143]
  v_fmac_f32 v46, v158, v246
  v_fmac_f32 v47, v159, v246
  v_fmac_f32 v32, v160, v246
  v_fmac_f32_e64 v33, v161, v246
  s_waitcnt vmcnt(1)
  v_mfma_f32_32x32x16_bf16 v[128:143], a[108:111], v[204:207], v[128:143]
  s_waitcnt vmcnt(0)
  v_cmp_gt_i32 vcc, 10, v31
  s_cbranch_vccz L66
  s_mov_b32 s44, 0
L67:
  buffer_load_dword v31, v254, s[16:19], s41 offen sc1
  s_add_u32 s44, s44, 1
  s_cmp_gt_u32 s44, 200000
  s_cbranch_scc1 Lend
  s_waitcnt vmcnt(0)
  v_cmp_gt_i32_e64 vcc, 10, v31
  s_cbranch_vccnz L67
L66:
  s_cmp_eq_u32 s40, 0
  s_cbranch_scc1 L68
  buffer_inv sc1
  s_waitcnt vmcnt(0)
L68:
  buffer_load_dwordx4 v[80:83], v15, s[12:15], s76 offen offset:0 sc1
  buffer_load_dwordx4 v[84:87], v15, s[12:15], s76 offen offset:32 sc1
  v_mfma_f32_32x32x16_bf16 v[112:127], a[72:75], v[188:191], v[112:127]
  v_fmac_f32 v34, v162, v246
  v_fmac_f32 v35, v163, v246
  v_fmac_f32 v36, v164, v246
  v_fmac_f32_e64 v37, v165, v246
  v_mfma_f32_32x32x16_bf16 v[112:127], a[80:83], v[192:195], v[112:127]
  ds_write_b128 v18, v[128:131] offset:0
  ds_write_b128 v18, v[132:135] offset:1024
  ds_write_b128 v18, v[136:139] offset:2048
  ds_write_b128 v18, v[140:143] offset:3072
  v_mfma_f32_32x32x16_bf16 v[112:127], a[88:91], v[196:199], v[112:127]
  s_waitcnt lgkmcnt(0)
  s_barrier
  ds_read_b128 v[208:211], v20 offset:0
  ds_read_b128 v[212:215], v20 offset:1024
  v_mfma_f32_32x32x16_bf16 v[112:127], a[96:99], v[200:203], v[112:127]
  ds_read_b128 v[216:219], v20 offset:2048
  ds_read_b128 v[220:223], v20 offset:3072
  v_fmac_f32 v38, v166, v246
  v_fmac_f32 v39, v167, v246
  v_mfma_f32_32x32x16_bf16 v[112:127], a[104:107], v[204:207], v[112:127]
  v_fmac_f32 v40, v168, v246
  v_fmac_f32 v41, v169, v246
  v_fmac_f32 v42, v170, v246
  v_fmac_f32_e64 v43, v171, v246
  s_waitcnt vmcnt(0)
  v_mfma_f32_32x32x16_bf16 v[112:127], v[240:243], v[80:83], v[112:127]
  v_mfma_f32_32x32x16_bf16 v[112:127], v[248:251], v[84:87], v[112:127]
  v_pk_fma_f32 v[44:45], v[172:173], v[246:247], v[44:45] op_sel_hi:[1,0,1]
  v_pk_fma_f32 v[46:47], v[174:175], v[246:247], v[46:47] op_sel_hi:[1,0,1]
  s_waitcnt lgkmcnt(3)
  v_pk_fma_f32 v[32:33], v[208:209], v[246:247], v[32:33] op_sel_hi:[1,0,1]
  v_pk_fma_f32 v[34:35], v[210:211], v[246:247], v[34:35] op_sel_hi:[1,0,1]
  s_waitcnt lgkmcnt(2)
  v_pk_fma_f32 v[36:37], v[212:213], v[246:247], v[36:37] op_sel_hi:[1,0,1]
  v_pk_fma_f32 v[38:39], v[214:215], v[246:247], v[38:39] op_sel_hi:[1,0,1]
  s_waitcnt lgkmcnt(1)
  v_pk_fma_f32 v[40:41], v[216:217], v[246:247], v[40:41] op_sel_hi:[1,0,1]
  v_pk_fma_f32 v[42:43], v[218:219], v[246:247], v[42:43] op_sel_hi:[1,0,1]
  s_waitcnt lgkmcnt(0)
  v_pk_fma_f32 v[44:45], v[220:221], v[246:247], v[44:45] op_sel_hi:[1,0,1]
  v_pk_fma_f32 v[46:47], v[222:223], v[246:247], v[46:47] op_sel_hi:[1,0,1]
  v_pk_fma_f32 v[32:33], v[112:113], v[246:247], v[32:33] op_sel_hi:[1,0,1]
  v_pk_fma_f32 v[34:35], v[114:115], v[246:247], v[34:35] op_sel_hi:[1,0,1]
  v_cvt_pk_bf16_f32 v176, v32, v33
  v_cvt_pk_bf16_f32 v177, v34, v35
  v_pk_fma_f32 v[36:37], v[116:117], v[246:247], v[36:37] op_sel_hi:[1,0,1]
  v_pk_fma_f32 v[38:39], v[118:119], v[246:247], v[38:39] op_sel_hi:[1,0,1]
  v_cvt_pk_bf16_f32 v178, v36, v37
  v_cvt_pk_bf16_f32 v179, v38, v39
  v_pk_fma_f32 v[40:41], v[120:121], v[246:247], v[40:41] op_sel_hi:[1,0,1]
  v_pk_fma_f32 v[42:43], v[122:123], v[246:247], v[42:43] op_sel_hi:[1,0,1]
  v_cvt_pk_bf16_f32 v180, v40, v41
  v_cvt_pk_bf16_f32 v181, v42, v43
  v_pk_fma_f32 v[44:45], v[124:125], v[246:247], v[44:45] op_sel_hi:[1,0,1]
  v_pk_fma_f32 v[46:47], v[126:127], v[246:247], v[46:47] op_sel_hi:[1,0,1]
  v_cvt_pk_bf16_f32 v182, v44, v45
  v_cvt_pk_bf16_f32 v183, v46, v47
  v_permlane32_swap_b32 v176, v178
  v_permlane32_swap_b32 v177, v179
  v_permlane32_swap_b32 v180, v182
  v_permlane32_swap_b32 v181, v183
  buffer_store_dwordx4 v[176:179], v15, s[12:15], s60 offen offset:0
  buffer_store_dwordx4 v[180:183], v15, s[12:15], s60 offen offset:32
  s_endpgm
L20:
  buffer_load_dword v192, v236, s[16:19], s74 offen offset:512 sc1
  buffer_load_dwordx4 v[176:179], v235, s[16:19], s72 offen offset:0 sc1
  buffer_load_dwordx4 v[180:183], v235, s[16:19], s72 offen offset:2560 sc1
  buffer_load_dwordx4 v[184:187], v235, s[16:19], s73 offen offset:0 sc1
  buffer_load_dwordx4 v[188:191], v235, s[16:19], s73 offen offset:2560 sc1
  s_add_u32 s44, s44, 1
  s_cmp_gt_u32 s44, 200000
  s_cbranch_scc1 Lend
  s_waitcnt vmcnt(0)
  s_branch L19
L48:
  buffer_load_dword v192, v236, s[16:19], s74 offen offset:512 sc1
  buffer_load_dwordx4 v[176:179], v235, s[16:19], s72 offen offset:0 sc1
  buffer_load_dwordx4 v[180:183], v235, s[16:19], s72 offen offset:2560 sc1
  buffer_load_dwordx4 v[184:187], v235, s[16:19], s73 offen offset:0 sc1
  buffer_load_dwordx4 v[188:191], v235, s[16:19], s73 offen offset:2560 sc1
  s_add_u32 s44, s44, 1
  s_cmp_gt_u32 s44, 200000
  s_cbranch_scc1 Lend
  s_waitcnt vmcnt(0)
  s_branch L47
Lend:
  s_endpgm
.section .rodata,"a"
.p2align 6
.amdhsa_kernel interleave_layers__linear_attn_block__dense_activation_relu__prompt_kernel
  .amdhsa_next_free_vgpr 512
  .amdhsa_next_free_sgpr 102
  .amdhsa_accum_offset 256
  .amdhsa_group_segment_fixed_size 0
  .amdhsa_kernarg_size 72
  .amdhsa_user_sgpr_count 2
  .amdhsa_user_sgpr_kernarg_segment_ptr 1
  .amdhsa_system_sgpr_workgroup_id_x 1
.end_amdhsa_kernel
```
